```python
import torch

def _softmax(x, axis=-1):
    return torch.softmax(x, dim=axis)
def _gelu(x):
    return torch.nn.functional.gelu(x, approximate="tanh")
def _silu(x):
    return torch.nn.functional.silu(x)
def _sigmoid(x):
    return torch.sigmoid(x)
def _layernorm(x, axis=-1, eps=1e-5):
    m = x.mean(dim=axis, keepdim=True)
    v = x.var(dim=axis, keepdim=True, unbiased=False)
    return (x - m) / torch.sqrt(v + eps)
def _scatter_add(tgt, idx, src, axis=0):
    return tgt.clone().index_add_(axis, idx, src)
def _segment_sum(src, seg, n):
    out = torch.zeros((n,) + src.shape[1:], dtype=src.dtype)
    return out.index_add_(0, seg, src)
def _pad(x, pw):
    flat = tuple(v for pair in reversed(pw) for v in pair)
    return torch.nn.functional.pad(x, flat)

kernel_name = 'concat_heads__mha_block__ssm_conv_s4d__prompt'

def setup_inputs():

    _w = (lambda a: (lambda t: t.to(torch.bfloat16) if t.is_floating_point() else t)(torch.as_tensor(a)))
    def _A_setup():
        B, S, D, H = 1, 2048, 448, 16
        return {
            "x": _w((lambda *s: torch.randn(*s, dtype=torch.bfloat16) * 0.2)(B, S, D)),
            "wqkv": _w((lambda *s: torch.randn(*s, dtype=torch.bfloat16) * 0.2)(D, 3 * D)),
            "wo": _w((lambda *s: torch.randn(*s, dtype=torch.bfloat16) * 0.05)(D, D)),
        }
    _A_in = _A_setup()

    def _B_setup():
        Bsz, L, D, N = 1, 2048, 448, 256
        return {
            "u": _w((lambda *s: torch.randn(*s, dtype=torch.bfloat16) * 0.05)(Bsz, L, D)),
            "log_A_real": _w((lambda *s: torch.randn(*s, dtype=torch.bfloat16) * 6.4)(D, N) * 0.5),
            "A_imag": _w((lambda *s: torch.randn(*s, dtype=torch.bfloat16) * 0.1)(D, N) * 3.14),
            "C_real": _w((lambda *s: torch.randn(*s, dtype=torch.bfloat16) * 0.4)(D, N) / N ** 0.5),
            "C_imag": _w((lambda *s: torch.randn(*s, dtype=torch.bfloat16) * 0.4)(D, N) / N ** 0.5),
            "log_dt": _w((lambda *s: torch.randn(*s, dtype=torch.bfloat16) * 0.1)(D) * 0.5 - 4.0),
            "D_skip": _w((lambda *s: torch.randn(*s, dtype=torch.bfloat16) * 0.1)(D)),
        }
    _B_in = _B_setup()

    return {
        "A_x": _A_in["x"],
        "A_wqkv": _A_in["wqkv"],
        "A_wo": _A_in["wo"],
        "B_u": _B_in["u"],
        "B_log_A_real": _B_in["log_A_real"],
        "B_A_imag": _B_in["A_imag"],
        "B_C_real": _B_in["C_real"],
        "B_C_imag": _B_in["C_imag"],
        "B_log_dt": _B_in["log_dt"],
        "B_D_skip": _B_in["D_skip"],
    }

def reference(A_x, A_wqkv, A_wo, B_u, B_log_A_real, B_A_imag, B_C_real, B_C_imag, B_log_dt, B_D_skip):
    def _A_ref(x, wqkv, wo):
        B, S, D = x.shape
        H = 16
        Dh = D // H
        qkv = (lambda x, *d: x.permute(*d))((x @ wqkv).reshape(B, S, 3, H, Dh), 2, 0, 3, 1, 4)
        q, k, v = qkv[0], qkv[1], qkv[2]
        scores = torch.einsum("bhqd,bhkd->bhqk", q, k) * (Dh ** -0.5)
        p = _softmax(scores, axis=-1)
        o = torch.einsum("bhqk,bhkd->bhqd", p, v)
        return (lambda x, *d: x.permute(*d))(o, 0, 2, 1, 3).reshape(B, S, D) @ wo

    def _B_ref(u, log_A_real, A_imag, C_real, C_imag, log_dt, D_skip):
        L = u.shape[1]
        dt = torch.exp(log_dt)
        A = -torch.exp(log_A_real) + 1j * A_imag
        C = (C_real + 1j * C_imag) * dt[:, None]
        pos = (lambda x, dt: x.to(dt))(torch.arange(L), log_dt.dtype)
        P = torch.exp((A * dt[:, None])[:, :, None] * pos[None, None, :])
        K = 2.0 * torch.einsum("dn,dnl->dl", C, P).real
        L2 = 2 * L
        u_t = (lambda x, *d: x.permute(*d))(u, 0, 2, 1)
        Kf = (lambda x, *a, **k: torch.fft.rfft(x.float(), *a, **k))(K, L2)
        Uf = (lambda x, *a, **k: torch.fft.rfft(x.float(), *a, **k))(u_t, L2)
        y = (lambda x, *a, **k: torch.fft.irfft(x, *a, **k).to(torch.bfloat16))(Uf * Kf[None, :, :], L2)[:, :, :L]
        y = (lambda x, *d: x.permute(*d))(y, 0, 2, 1)
        return y + u * D_skip[None, None, :]

    a = _A_ref(A_x, A_wqkv, A_wo)
    b = _B_ref(B_u, B_log_A_real, B_A_imag, B_C_real, B_C_imag, B_log_dt, B_D_skip)
    return torch.concatenate([a, b], axis=-1)
```

```asm
; @launch grid=(256,1,1) block=(512,1,1) lds=163840
.amdgcn_target "amdgcn-amd-amdhsa--gfx950"
.text
.globl concat_heads__mha_block__ssm_conv_s4d__prompt_kernel
.p2align 8
.type concat_heads__mha_block__ssm_conv_s4d__prompt_kernel,@function
concat_heads__mha_block__ssm_conv_s4d__prompt_kernel:
    s_cmp_ge_u32 s2, 256
    s_cbranch_scc1 L_end
    s_load_dwordx16 s[64:79], s[0:1], 0
    s_load_dwordx8 s[80:87], s[0:1], 64
    s_load_dwordx2 s[88:89], s[0:1], 96
    v_lshrrev_b32 v1, 6, v0
    s_and_b32 s50, s2, 7
    s_lshr_b32 s41, s2, 3
    s_add_u32 s41, s41, 28
    s_and_b32 s41, s41, 31
    v_readfirstlane_b32 s36, v1
    s_cmp_ge_u32 s2, 32
    s_cbranch_scc1 Lnpf
    s_getpc_b64 s[54:55]
Lpc:
    v_lshlrev_b32 v2, 7, v0
    v_cmp_gt_u32 vcc, L_end-Lpc, v2
    s_and_saveexec_b64 s[56:57], vcc
    s_cbranch_execz Lnpf0
    global_load_dword v250, v2, s[54:55]
Lnpf0:
    s_mov_b64 exec, -1
Lnpf:
    v_and_b32 v0, 63, v0
    s_and_b32 s52, s41, 1
    s_lshl_b32 s39, s50, 1
    s_add_u32 s39, s39, s52
    s_lshr_b32 s40, s2, 4
    v_lshlrev_b32 v6, 2, v0
    v_add_u32 v7, 162048, v6
    v_mov_b32 v8, 0
    ds_write_b32 v7, v8
    s_cmp_ge_u32 s41, 28
    s_cbranch_scc1 L_idle
    s_and_b32 s52, s50, 1
    s_mul_i32 s52, s52, 28
    s_add_u32 s52, s52, s41
    s_lshr_b32 s37, s52, 3
    s_and_b32 s52, s52, 7
    s_lshr_b32 s38, s50, 1
    s_lshl_b32 s38, s38, 3
    s_add_u32 s38, s38, s52
    s_and_b32 s42, s36, 3
    s_lshr_b32 s43, s42, 1
    s_and_b32 s44, s42, 1
    s_lshl_b32 s47, s37, 5
    s_add_u32 s47, s47, s38
    s_lshl_b32 s47, s47, 2
    s_add_u32 s53, s47, s42
    s_lshl_b32 s53, s53, 8
    v_add_u32 v6, s53, v6
    v_lshrrev_b32 v14, 3, v0
    v_and_b32 v15, 7, v0
    s_lshl_b32 s90, s42, 4
    v_add_u32 v1, s90, v14
    v_lshrrev_b32 v14, 1, v14
    v_xor_b32 v2, v15, v14
    v_lshlrev_b32 v2, 4, v2
    v_mul_u32_u24 v3, 896, v1
    v_add_u32 v2, v2, v3
    v_xor_b32 v3, 64, v2
    v_add_u32 v3, 7168, v3
    v_and_b32 v14, 1, v14
    v_lshlrev_b32 v14, 2, v14
    v_xor_b32 v14, v15, v14
    v_lshlrev_b32 v14, 4, v14
    v_mul_u32_u24 v4, 2688, v1
    v_add_u32 v4, v4, v14
    v_add_u32 v5, 21504, v4
    s_lshl_b32 s90, s42, 11
    s_lshl_b32 s91, s37, 1
    s_add_u32 s92, s52, s91
    s_add_u32 s92, s92, s52
    s_mul_i32 s91, s92, 37
    s_lshr_b32 s91, s91, 8
    s_mul_i32 s91, s91, 7
    s_sub_u32 s92, s92, s91
    s_mul_i32 s93, s38, 57344
    s_lshl_b32 s94, s37, 7
    s_cmp_lt_u32 s36, 4
    s_cbranch_scc1 L_A
    v_lshrrev_b32 v7, 1, v0
    v_mul_u32_u24 v7, 896, v7
    v_and_b32 v8, 1, v0
    v_lshl_add_u32 v7, v8, 4, v7
    s_lshl_b32 s55, s42, 5
    s_add_u32 s55, s55, s93
    s_add_u32 s55, s55, s94
    v_add_u32 v7, s55, v7
    v_add_u32 v8, 28672, v7
    s_waitcnt lgkmcnt(0)
    global_load_dword v12, v6, s[72:73]
    global_load_dword v13, v6, s[74:75]
    global_load_dword v14, v6, s[76:77]
    global_load_dword v15, v6, s[78:79]
    global_load_dwordx4 v[168:171], v7, s[70:71]
    global_load_dwordx4 v[172:175], v8, s[70:71]
    s_load_dword s48, s[80:81], s47
    s_load_dword s49, s[82:83], s47
    s_barrier
    s_branch L_B
L_A:
    s_setprio 2
    s_waitcnt lgkmcnt(0)
    s_mov_b32 s8, s64
    s_mov_b32 s9, s65
    s_mov_b32 s10, 1835008
    s_mov_b32 s11, 0x00020000
    s_mov_b32 s12, s66
    s_mov_b32 s13, s67
    s_mov_b32 s14, 1204224
    s_mov_b32 s15, 0x00020000
    s_mov_b32 s4, s88
    s_mov_b32 s5, s89
    s_mov_b32 s6, 16777216
    s_mov_b32 s7, 0x00020000
    s_mov_b32 s28, s86
    s_mov_b32 s29, s87
    s_mov_b32 s30, 256
    s_mov_b32 s31, 0x00020000
    s_lshl_b32 s76, s92, 7
    s_add_u32 s76, s76, s93
    s_mul_i32 s83, s92, 172032
    s_add_u32 s83, s83, s94
    s_add_u32 s92, s92, 1
    s_cmp_eq_u32 s92, 7
    s_cselect_b32 s92, 0, s92
    s_barrier
    s_add_u32 m0, s90, 47360
    s_nop 0
    buffer_load_dwordx4 v2, s[8:11], s76 offen lds
    s_add_u32 m0, s90, 48384
    s_nop 0
    buffer_load_dwordx4 v3, s[8:11], s76 offen lds
    s_add_u32 m0, s90, 55552
    s_add_u32 s91, s83, 896
    buffer_load_dwordx4 v4, s[12:15], s91 offen lds
    s_add_u32 m0, s90, 56576
    s_nop 0
    buffer_load_dwordx4 v5, s[12:15], s91 offen lds
    s_add_u32 m0, s90, 63744
    s_add_u32 s91, s83, 1792
    buffer_load_dwordx4 v4, s[12:15], s91 offen lds
    s_add_u32 m0, s90, 64768
    s_nop 0
    buffer_load_dwordx4 v5, s[12:15], s91 offen lds
    v_and_b32 v14, 31, v0
    v_lshrrev_b32 v15, 5, v0
    v_lshrrev_b32 v1, 1, v14
    v_and_b32 v1, 7, v1
    v_xor_b32 v1, v1, v15
    v_lshlrev_b32 v1, 4, v1
    v_lshl_add_u32 v6, v14, 7, v1
    s_lshl_b32 s55, s43, 12
    v_xor_b32 v7, 32, v6
    v_xor_b32 v8, 64, v6
    v_xor_b32 v9, 96, v6
    s_add_u32 s55, s55, 47360
    v_add_u32 v6, s55, v6
    v_add_u32 v7, s55, v7
    v_add_u32 v8, s55, v8
    v_add_u32 v9, s55, v9
    v_add_u32 v245, 0x10000, v6
    v_add_u32 v246, 0x10000, v7
    v_add_u32 v247, 0x10000, v8
    v_add_u32 v248, 0x10000, v9
    v_bfe_u32 v1, v0, 2, 2
    v_lshl_add_u32 v10, v15, 3, v1
    v_lshlrev_b32 v10, 7, v10
    v_lshrrev_b32 v1, 1, v1
    v_xor_b32 v1, s44, v1
    v_lshl_add_u32 v10, v1, 6, v10
    v_bfe_u32 v1, v0, 4, 1
    v_lshl_add_u32 v10, v1, 5, v10
    v_and_b32 v1, 1, v0
    v_lshl_add_u32 v10, v1, 4, v10
    v_bfe_u32 v1, v0, 1, 1
    v_lshl_add_u32 v10, v1, 3, v10
    v_add_u32 v10, 47360, v10
    v_add_u32 v11, 0x10000, v10
    s_lshl_b32 s77, s92, 7
    s_add_u32 s77, s77, s93
    s_mul_i32 s84, s92, 172032
    s_add_u32 s84, s84, s94
    s_add_u32 s92, s92, 1
    s_cmp_eq_u32 s92, 7
    s_cselect_b32 s92, 0, s92
    s_add_u32 m0, s90, 71936
    s_nop 0
    buffer_load_dwordx4 v2, s[8:11], s77 offen lds
    s_add_u32 m0, s90, 72960
    s_nop 0
    buffer_load_dwordx4 v3, s[8:11], s77 offen lds
    s_add_u32 m0, s90, 80128
    s_add_u32 s91, s84, 896
    buffer_load_dwordx4 v4, s[12:15], s91 offen lds
    s_add_u32 m0, s90, 81152
    s_nop 0
    buffer_load_dwordx4 v5, s[12:15], s91 offen lds
    s_add_u32 m0, s90, 88320
    s_add_u32 s91, s84, 1792
    buffer_load_dwordx4 v4, s[12:15], s91 offen lds
    s_add_u32 m0, s90, 89344
    s_nop 0
    buffer_load_dwordx4 v5, s[12:15], s91 offen lds
    v_lshlrev_b32 v12, 4, v0
    v_and_b32 v13, 0x13, v14
    v_bfe_u32 v1, v14, 2, 1
    v_lshl_add_u32 v13, v1, 3, v13
    v_bfe_u32 v1, v14, 3, 1
    v_lshl_add_u32 v13, v1, 2, v13
    v_lshlrev_b32 v13, 4, v13
    v_mul_u32_u24 v1, 7168, v15
    v_add_u32 v13, v13, v1
    s_lshl_b32 s55, s38, 1
    s_add_u32 s55, s55, s43
    s_lshl_b32 s56, s37, 1
    s_add_u32 s56, s56, s44
    s_lshl_b32 s95, s56, 6
    s_add_u32 s95, s95, s55
    s_lshl_b32 s95, s95, 7
    s_add_u32 s95, s95, 12582912
    s_mul_i32 s55, s55, 28672
    s_lshl_b32 s53, s56, 11
    s_add_u32 s53, s53, s55
    s_add_u32 s50, s53, 2097152
    s_lshl_b32 s51, s56, 9
    s_add_u32 s51, s51, s55
    s_add_u32 s51, s51, 4194304
    s_add_u32 s52, s51, 14336
    s_mov_b32 s54, 0x3e8b97f6
    v_mov_b32 v240, 162048
    v_mov_b32 v241, 1
    v_mov_b32 v224, -1
    v_mov_b32 v225, -1
    v_mov_b32 v226, -1
    v_mov_b32 v227, -1
    buffer_store_dwordx4 v[224:227], v12, s[4:7], s53 offen sc1
    buffer_store_dwordx4 v[224:227], v12, s[4:7], s53 offen offset:1024 sc1
    s_waitcnt vmcnt(8) lgkmcnt(0)
    s_barrier
    ds_read_b128 v[16:19], v6 offset:0
    ds_read_b64_tr_b16 v[128:129], v10 offset:8192
    ds_read_b64_tr_b16 v[130:131], v10 offset:8704
    ds_read_b64_tr_b16 v[132:133], v10 offset:16384
    ds_read_b64_tr_b16 v[134:135], v10 offset:16896
    ds_read_b128 v[20:23], v7 offset:0
    ds_read_b64_tr_b16 v[136:137], v10 offset:10240
    ds_read_b64_tr_b16 v[138:139], v10 offset:10752
    ds_read_b64_tr_b16 v[140:141], v10 offset:18432
    ds_read_b64_tr_b16 v[142:143], v10 offset:18944
    ds_read_b128 v[24:27], v8 offset:0
    ds_read_b64_tr_b16 v[144:145], v10 offset:12288
    ds_read_b64_tr_b16 v[146:147], v10 offset:12800
    ds_read_b64_tr_b16 v[148:149], v10 offset:20480
    ds_read_b64_tr_b16 v[150:151], v10 offset:20992
    ds_read_b128 v[28:31], v9 offset:0
    ds_read_b64_tr_b16 v[152:153], v10 offset:14336
    ds_read_b64_tr_b16 v[154:155], v10 offset:14848
    ds_read_b64_tr_b16 v[156:157], v10 offset:22528
    ds_read_b64_tr_b16 v[158:159], v10 offset:23040
    s_waitcnt vmcnt(2) lgkmcnt(0)
    s_barrier
    v_mfma_f32_32x32x16_bf16 v[192:207], v[128:131], v[16:19], 0
    ds_read_b128 v[32:35], v6 offset:24576
    ds_read_b64_tr_b16 v[160:161], v10 offset:32768
    ds_read_b64_tr_b16 v[162:163], v10 offset:33280
    v_mfma_f32_32x32x16_bf16 v[208:223], v[16:19], v[132:135], 0
    ds_read_b64_tr_b16 v[164:165], v10 offset:40960
    ds_read_b64_tr_b16 v[166:167], v10 offset:41472
    ds_read_b128 v[36:39], v7 offset:24576
    v_mfma_f32_32x32x16_bf16 v[192:207], v[136:139], v[20:23], v[192:207]
    ds_read_b64_tr_b16 v[168:169], v10 offset:34816
    ds_read_b64_tr_b16 v[170:171], v10 offset:35328
    ds_read_b64_tr_b16 v[172:173], v10 offset:43008
    v_mfma_f32_32x32x16_bf16 v[208:223], v[20:23], v[140:143], v[208:223]
    ds_read_b64_tr_b16 v[174:175], v10 offset:43520
    ds_read_b128 v[40:43], v8 offset:24576
    ds_read_b64_tr_b16 v[176:177], v10 offset:36864
    v_mfma_f32_32x32x16_bf16 v[192:207], v[144:147], v[24:27], v[192:207]
    ds_read_b64_tr_b16 v[178:179], v10 offset:37376
    ds_read_b64_tr_b16 v[180:181], v10 offset:45056
    ds_read_b64_tr_b16 v[182:183], v10 offset:45568
    v_mfma_f32_32x32x16_bf16 v[208:223], v[24:27], v[148:151], v[208:223]
    ds_read_b128 v[44:47], v9 offset:24576
    ds_read_b64_tr_b16 v[184:185], v10 offset:38912
    ds_read_b64_tr_b16 v[186:187], v10 offset:39424
    v_mfma_f32_32x32x16_bf16 v[192:207], v[152:155], v[28:31], v[192:207]
    ds_read_b64_tr_b16 v[188:189], v10 offset:47104
    ds_read_b64_tr_b16 v[190:191], v10 offset:47616
    v_mfma_f32_32x32x16_bf16 v[208:223], v[28:31], v[156:159], v[208:223]
    s_waitcnt lgkmcnt(0)
    s_barrier
    v_mfma_f32_32x32x16_bf16 v[192:207], v[160:163], v[32:35], v[192:207]
    ds_read_b128 v[48:51], v6 offset:49152
    ds_read_b64_tr_b16 v[128:129], v10 offset:57344
    ds_read_b64_tr_b16 v[130:131], v10 offset:57856
    v_mfma_f32_32x32x16_bf16 v[208:223], v[32:35], v[164:167], v[208:223]
    ds_read_b64_tr_b16 v[132:133], v11 offset:0
    ds_read_b64_tr_b16 v[134:135], v11 offset:512
    ds_read_b128 v[52:55], v7 offset:49152
    v_mfma_f32_32x32x16_bf16 v[192:207], v[168:171], v[36:39], v[192:207]
    ds_read_b64_tr_b16 v[136:137], v10 offset:59392
    ds_read_b64_tr_b16 v[138:139], v10 offset:59904
    ds_read_b64_tr_b16 v[140:141], v11 offset:2048
    v_mfma_f32_32x32x16_bf16 v[208:223], v[36:39], v[172:175], v[208:223]
    ds_read_b64_tr_b16 v[142:143], v11 offset:2560
    ds_read_b128 v[56:59], v8 offset:49152
    ds_read_b64_tr_b16 v[144:145], v10 offset:61440
    v_mfma_f32_32x32x16_bf16 v[192:207], v[176:179], v[40:43], v[192:207]
    ds_read_b64_tr_b16 v[146:147], v10 offset:61952
    ds_read_b64_tr_b16 v[148:149], v11 offset:4096
    ds_read_b64_tr_b16 v[150:151], v11 offset:4608
    v_mfma_f32_32x32x16_bf16 v[208:223], v[40:43], v[180:183], v[208:223]
    ds_read_b128 v[60:63], v9 offset:49152
    ds_read_b64_tr_b16 v[152:153], v10 offset:63488
    ds_read_b64_tr_b16 v[154:155], v10 offset:64000
    v_mfma_f32_32x32x16_bf16 v[192:207], v[184:187], v[44:47], v[192:207]
    ds_read_b64_tr_b16 v[156:157], v11 offset:6144
    ds_read_b64_tr_b16 v[158:159], v11 offset:6656
    v_mfma_f32_32x32x16_bf16 v[208:223], v[44:47], v[188:191], v[208:223]
    s_waitcnt lgkmcnt(0)
    s_barrier
    v_mfma_f32_32x32x16_bf16 v[192:207], v[128:131], v[48:51], v[192:207]
    ds_read_b128 v[64:67], v245 offset:8192
    ds_read_b64_tr_b16 v[160:161], v11 offset:16384
    ds_read_b64_tr_b16 v[162:163], v11 offset:16896
    v_mfma_f32_32x32x16_bf16 v[208:223], v[48:51], v[132:135], v[208:223]
    ds_read_b64_tr_b16 v[164:165], v11 offset:24576
    ds_read_b64_tr_b16 v[166:167], v11 offset:25088
    ds_read_b128 v[68:71], v246 offset:8192
    v_mfma_f32_32x32x16_bf16 v[192:207], v[136:139], v[52:55], v[192:207]
    ds_read_b64_tr_b16 v[168:169], v11 offset:18432
    ds_read_b64_tr_b16 v[170:171], v11 offset:18944
    ds_read_b64_tr_b16 v[172:173], v11 offset:26624
    v_mfma_f32_32x32x16_bf16 v[208:223], v[52:55], v[140:143], v[208:223]
    ds_read_b64_tr_b16 v[174:175], v11 offset:27136
    ds_read_b128 v[72:75], v247 offset:8192
    ds_read_b64_tr_b16 v[176:177], v11 offset:20480
    v_mfma_f32_32x32x16_bf16 v[192:207], v[144:147], v[56:59], v[192:207]
    ds_read_b64_tr_b16 v[178:179], v11 offset:20992
    ds_read_b64_tr_b16 v[180:181], v11 offset:28672
    ds_read_b64_tr_b16 v[182:183], v11 offset:29184
    v_mfma_f32_32x32x16_bf16 v[208:223], v[56:59], v[148:151], v[208:223]
    ds_read_b128 v[76:79], v248 offset:8192
    ds_read_b64_tr_b16 v[184:185], v11 offset:22528
    ds_read_b64_tr_b16 v[186:187], v11 offset:23040
    v_mfma_f32_32x32x16_bf16 v[192:207], v[152:155], v[60:63], v[192:207]
    ds_read_b64_tr_b16 v[188:189], v11 offset:30720
    ds_read_b64_tr_b16 v[190:191], v11 offset:31232
    v_mfma_f32_32x32x16_bf16 v[208:223], v[60:63], v[156:159], v[208:223]
    s_waitcnt lgkmcnt(0)
    s_barrier
    v_mfma_f32_32x32x16_bf16 v[192:207], v[160:163], v[64:67], v[192:207]
    ds_read_b128 v[80:83], v245 offset:32768
    ds_read_b64_tr_b16 v[128:129], v11 offset:40960
    ds_read_b64_tr_b16 v[130:131], v11 offset:41472
    v_mfma_f32_32x32x16_bf16 v[208:223], v[64:67], v[164:167], v[208:223]
    ds_read_b64_tr_b16 v[132:133], v10 offset:0
    ds_read_b64_tr_b16 v[134:135], v10 offset:512
    ds_read_b128 v[84:87], v246 offset:32768
    v_mfma_f32_32x32x16_bf16 v[192:207], v[168:171], v[68:71], v[192:207]
    ds_read_b64_tr_b16 v[136:137], v11 offset:43008
    ds_read_b64_tr_b16 v[138:139], v11 offset:43520
    ds_read_b64_tr_b16 v[140:141], v10 offset:2048
    buffer_load_dword v243, off, s[28:31], 0 sc1
    v_mfma_f32_32x32x16_bf16 v[208:223], v[68:71], v[172:175], v[208:223]
    ds_read_b64_tr_b16 v[142:143], v10 offset:2560
    ds_read_b128 v[88:91], v247 offset:32768
    ds_read_b64_tr_b16 v[144:145], v11 offset:45056
    v_mfma_f32_32x32x16_bf16 v[192:207], v[176:179], v[72:75], v[192:207]
    ds_read_b64_tr_b16 v[146:147], v11 offset:45568
    ds_read_b64_tr_b16 v[148:149], v10 offset:4096
    ds_read_b64_tr_b16 v[150:151], v10 offset:4608
    v_mfma_f32_32x32x16_bf16 v[208:223], v[72:75], v[180:183], v[208:223]
    ds_read_b128 v[92:95], v248 offset:32768
    ds_read_b64_tr_b16 v[152:153], v11 offset:47104
    ds_read_b64_tr_b16 v[154:155], v11 offset:47616
    v_mfma_f32_32x32x16_bf16 v[192:207], v[184:187], v[76:79], v[192:207]
    ds_read_b64_tr_b16 v[156:157], v10 offset:6144
    ds_read_b64_tr_b16 v[158:159], v10 offset:6656
    v_mfma_f32_32x32x16_bf16 v[208:223], v[76:79], v[188:191], v[208:223]
    s_waitcnt lgkmcnt(0)
    s_barrier
    v_mfma_f32_32x32x16_bf16 v[192:207], v[128:131], v[80:83], v[192:207]
    ds_read_b128 v[96:99], v6 offset:8192
    ds_read_b64_tr_b16 v[160:161], v10 offset:16384
    ds_read_b64_tr_b16 v[162:163], v10 offset:16896
    v_mfma_f32_32x32x16_bf16 v[208:223], v[80:83], v[132:135], v[208:223]
    ds_read_b64_tr_b16 v[164:165], v10 offset:24576
    ds_read_b64_tr_b16 v[166:167], v10 offset:25088
    ds_read_b128 v[100:103], v7 offset:8192
    v_mfma_f32_32x32x16_bf16 v[192:207], v[136:139], v[84:87], v[192:207]
    ds_read_b64_tr_b16 v[168:169], v10 offset:18432
    ds_read_b64_tr_b16 v[170:171], v10 offset:18944
    ds_read_b64_tr_b16 v[172:173], v10 offset:26624
    v_mfma_f32_32x32x16_bf16 v[208:223], v[84:87], v[140:143], v[208:223]
    ds_read_b64_tr_b16 v[174:175], v10 offset:27136
    ds_read_b128 v[104:107], v8 offset:8192
    ds_read_b64_tr_b16 v[176:177], v10 offset:20480
    v_mfma_f32_32x32x16_bf16 v[192:207], v[144:147], v[88:91], v[192:207]
    ds_read_b64_tr_b16 v[178:179], v10 offset:20992
    ds_read_b64_tr_b16 v[180:181], v10 offset:28672
    ds_read_b64_tr_b16 v[182:183], v10 offset:29184
    v_mfma_f32_32x32x16_bf16 v[208:223], v[88:91], v[148:151], v[208:223]
    ds_read_b128 v[108:111], v9 offset:8192
    ds_read_b64_tr_b16 v[184:185], v10 offset:22528
    ds_read_b64_tr_b16 v[186:187], v10 offset:23040
    v_mfma_f32_32x32x16_bf16 v[192:207], v[152:155], v[92:95], v[192:207]
    ds_read_b64_tr_b16 v[188:189], v10 offset:30720
    ds_read_b64_tr_b16 v[190:191], v10 offset:31232
    v_mfma_f32_32x32x16_bf16 v[208:223], v[92:95], v[156:159], v[208:223]
    s_waitcnt lgkmcnt(0)
    s_barrier
    v_mfma_f32_32x32x16_bf16 v[192:207], v[160:163], v[96:99], v[192:207]
    ds_read_b128 v[112:115], v6 offset:32768
    ds_read_b64_tr_b16 v[128:129], v10 offset:40960
    ds_read_b64_tr_b16 v[130:131], v10 offset:41472
    v_mfma_f32_32x32x16_bf16 v[208:223], v[96:99], v[164:167], v[208:223]
    ds_read_b64_tr_b16 v[132:133], v10 offset:49152
    ds_read_b64_tr_b16 v[134:135], v10 offset:49664
    ds_read_b128 v[116:119], v7 offset:32768
    v_mfma_f32_32x32x16_bf16 v[192:207], v[168:171], v[100:103], v[192:207]
    ds_read_b64_tr_b16 v[136:137], v10 offset:43008
    ds_read_b64_tr_b16 v[138:139], v10 offset:43520
    ds_read_b64_tr_b16 v[140:141], v10 offset:51200
    v_mfma_f32_32x32x16_bf16 v[208:223], v[100:103], v[172:175], v[208:223]
    ds_read_b64_tr_b16 v[142:143], v10 offset:51712
    ds_read_b128 v[120:123], v8 offset:32768
    ds_read_b64_tr_b16 v[144:145], v10 offset:45056
    v_mfma_f32_32x32x16_bf16 v[192:207], v[176:179], v[104:107], v[192:207]
    ds_read_b64_tr_b16 v[146:147], v10 offset:45568
    ds_read_b64_tr_b16 v[148:149], v10 offset:53248
    ds_read_b64_tr_b16 v[150:151], v10 offset:53760
    v_mfma_f32_32x32x16_bf16 v[208:223], v[104:107], v[180:183], v[208:223]
    ds_read_b128 v[124:127], v9 offset:32768
    ds_read_b64_tr_b16 v[152:153], v10 offset:47104
    ds_read_b64_tr_b16 v[154:155], v10 offset:47616
    v_mfma_f32_32x32x16_bf16 v[192:207], v[184:187], v[108:111], v[192:207]
    ds_read_b64_tr_b16 v[156:157], v10 offset:55296
    ds_read_b64_tr_b16 v[158:159], v10 offset:55808
    v_mfma_f32_32x32x16_bf16 v[208:223], v[108:111], v[188:191], v[208:223]
    s_waitcnt lgkmcnt(0)
    s_barrier
    v_mfma_f32_32x32x16_bf16 v[192:207], v[128:131], v[112:115], v[192:207]
    ds_read_b64_tr_b16 v[160:161], v10 offset:57344
    ds_read_b64_tr_b16 v[162:163], v10 offset:57856
    ds_read_b64_tr_b16 v[164:165], v10 offset:59392
    v_mfma_f32_32x32x16_bf16 v[208:223], v[112:115], v[132:135], v[208:223]
    ds_read_b64_tr_b16 v[166:167], v10 offset:59904
    ds_read_b64_tr_b16 v[168:169], v10 offset:61440
    ds_read_b64_tr_b16 v[170:171], v10 offset:61952
    v_mfma_f32_32x32x16_bf16 v[192:207], v[136:139], v[116:119], v[192:207]
    ds_read_b64_tr_b16 v[172:173], v10 offset:63488
    ds_read_b64_tr_b16 v[174:175], v10 offset:64000
    ds_read_b64_tr_b16 v[176:177], v11 offset:0
    v_mfma_f32_32x32x16_bf16 v[208:223], v[116:119], v[140:143], v[208:223]
    ds_read_b64_tr_b16 v[178:179], v11 offset:512
    ds_read_b64_tr_b16 v[180:181], v11 offset:2048
    ds_read_b64_tr_b16 v[182:183], v11 offset:2560
    v_mfma_f32_32x32x16_bf16 v[192:207], v[144:147], v[120:123], v[192:207]
    ds_read_b64_tr_b16 v[184:185], v11 offset:4096
    ds_read_b64_tr_b16 v[186:187], v11 offset:4608
    ds_read_b64_tr_b16 v[188:189], v11 offset:6144
    v_mfma_f32_32x32x16_bf16 v[208:223], v[120:123], v[148:151], v[208:223]
    ds_read_b64_tr_b16 v[190:191], v11 offset:6656
    v_mfma_f32_32x32x16_bf16 v[192:207], v[152:155], v[124:127], v[192:207]
    v_mfma_f32_32x32x16_bf16 v[208:223], v[124:127], v[156:159], v[208:223]
    s_waitcnt lgkmcnt(0)
    s_barrier
    v_mfma_f32_32x32x16_bf16 v[224:239], v[160:163], v[16:19], 0
    ds_read_b64_tr_b16 v[128:129], v11 offset:8192
    ds_read_b64_tr_b16 v[130:131], v11 offset:8704
    ds_read_b64_tr_b16 v[132:133], v11 offset:10240
    v_mfma_f32_32x32x16_bf16 v[224:239], v[164:167], v[20:23], v[224:239]
    ds_read_b64_tr_b16 v[134:135], v11 offset:10752
    ds_read_b64_tr_b16 v[136:137], v11 offset:12288
    ds_read_b64_tr_b16 v[138:139], v11 offset:12800
    v_mfma_f32_32x32x16_bf16 v[224:239], v[168:171], v[24:27], v[224:239]
    ds_read_b64_tr_b16 v[140:141], v11 offset:14336
    ds_read_b64_tr_b16 v[142:143], v11 offset:14848
    ds_read_b64_tr_b16 v[144:145], v11 offset:16384
    v_mul_f32 v192, s54, v192
    v_mul_f32 v193, s54, v193
    v_mul_f32 v194, s54, v194
    v_mul_f32 v195, s54, v195
    v_mul_f32 v196, s54, v196
    v_mul_f32 v197, s54, v197
    v_mfma_f32_32x32x16_bf16 v[224:239], v[172:175], v[28:31], v[224:239]
    ds_read_b64_tr_b16 v[146:147], v11 offset:16896
    ds_read_b64_tr_b16 v[148:149], v11 offset:18432
    ds_read_b64_tr_b16 v[150:151], v11 offset:18944
    v_mul_f32 v198, s54, v198
    v_mul_f32 v199, s54, v199
    v_mul_f32 v200, s54, v200
    v_mul_f32 v201, s54, v201
    v_mul_f32 v202, s54, v202
    v_mul_f32 v203, s54, v203
    v_mfma_f32_32x32x16_bf16 v[224:239], v[176:179], v[32:35], v[224:239]
    ds_read_b64_tr_b16 v[152:153], v11 offset:20480
    ds_read_b64_tr_b16 v[154:155], v11 offset:20992
    ds_read_b64_tr_b16 v[156:157], v11 offset:22528
    v_mul_f32 v204, s54, v204
    v_mul_f32 v205, s54, v205
    v_mul_f32 v206, s54, v206
    v_mul_f32 v207, s54, v207
    v_cvt_pk_bf16_f32 v192, v192, v193
    v_cvt_pk_bf16_f32 v193, v194, v195
    v_mfma_f32_32x32x16_bf16 v[224:239], v[180:183], v[36:39], v[224:239]
    ds_read_b64_tr_b16 v[158:159], v11 offset:23040
    v_cvt_pk_bf16_f32 v194, v196, v197
    v_cvt_pk_bf16_f32 v195, v198, v199
    v_cvt_pk_bf16_f32 v196, v200, v201
    v_cvt_pk_bf16_f32 v197, v202, v203
    v_cvt_pk_bf16_f32 v198, v204, v205
    v_cvt_pk_bf16_f32 v199, v206, v207
    v_mfma_f32_32x32x16_bf16 v[224:239], v[184:187], v[40:43], v[224:239]
    buffer_store_dwordx4 v[192:195], v12, s[4:7], s50 offen sc1
    buffer_store_dwordx4 v[196:199], v12, s[4:7], s50 offen offset:1024 sc1
    v_cvt_pk_bf16_f32 v208, v208, v209
    v_cvt_pk_bf16_f32 v209, v210, v211
    v_cvt_pk_bf16_f32 v210, v212, v213
    v_cvt_pk_bf16_f32 v211, v214, v215
    v_mfma_f32_32x32x16_bf16 v[224:239], v[188:191], v[44:47], v[224:239]
    v_cvt_pk_bf16_f32 v212, v216, v217
    v_cvt_pk_bf16_f32 v213, v218, v219
    v_cvt_pk_bf16_f32 v214, v220, v221
    v_cvt_pk_bf16_f32 v215, v222, v223
    buffer_store_dwordx4 v[208:211], v13, s[4:7], s51 offen sc1
    buffer_store_dwordx4 v[212:215], v13, s[4:7], s52 offen sc1
    s_waitcnt lgkmcnt(0)
    v_mfma_f32_32x32x16_bf16 v[224:239], v[128:131], v[48:51], v[224:239]
    ds_read_b64_tr_b16 v[160:161], v11 offset:24576
    ds_read_b64_tr_b16 v[162:163], v11 offset:25088
    ds_read_b64_tr_b16 v[164:165], v11 offset:26624
    v_mfma_f32_32x32x16_bf16 v[224:239], v[132:135], v[52:55], v[224:239]
    ds_read_b64_tr_b16 v[166:167], v11 offset:27136
    ds_read_b64_tr_b16 v[168:169], v11 offset:28672
    ds_read_b64_tr_b16 v[170:171], v11 offset:29184
    v_mfma_f32_32x32x16_bf16 v[224:239], v[136:139], v[56:59], v[224:239]
    ds_read_b64_tr_b16 v[172:173], v11 offset:30720
    ds_read_b64_tr_b16 v[174:175], v11 offset:31232
    ds_read_b64_tr_b16 v[176:177], v11 offset:32768
    v_mfma_f32_32x32x16_bf16 v[224:239], v[140:143], v[60:63], v[224:239]
    ds_read_b64_tr_b16 v[178:179], v11 offset:33280
    ds_read_b64_tr_b16 v[180:181], v11 offset:34816
    ds_read_b64_tr_b16 v[182:183], v11 offset:35328
    v_mfma_f32_32x32x16_bf16 v[224:239], v[144:147], v[64:67], v[224:239]
    ds_read_b64_tr_b16 v[184:185], v11 offset:36864
    ds_read_b64_tr_b16 v[186:187], v11 offset:37376
    ds_read_b64_tr_b16 v[188:189], v11 offset:38912
    v_mfma_f32_32x32x16_bf16 v[224:239], v[148:151], v[68:71], v[224:239]
    ds_read_b64_tr_b16 v[190:191], v11 offset:39424
    v_mfma_f32_32x32x16_bf16 v[224:239], v[152:155], v[72:75], v[224:239]
    v_mfma_f32_32x32x16_bf16 v[224:239], v[156:159], v[76:79], v[224:239]
    s_waitcnt lgkmcnt(0)
    v_mfma_f32_32x32x16_bf16 v[224:239], v[160:163], v[80:83], v[224:239]
    ds_read_b64_tr_b16 v[128:129], v11 offset:40960
    ds_read_b64_tr_b16 v[130:131], v11 offset:41472
    ds_read_b64_tr_b16 v[132:133], v11 offset:43008
    v_mfma_f32_32x32x16_bf16 v[224:239], v[164:167], v[84:87], v[224:239]
    ds_read_b64_tr_b16 v[134:135], v11 offset:43520
    ds_read_b64_tr_b16 v[136:137], v11 offset:45056
    ds_read_b64_tr_b16 v[138:139], v11 offset:45568
    v_mfma_f32_32x32x16_bf16 v[224:239], v[168:171], v[88:91], v[224:239]
    ds_read_b64_tr_b16 v[140:141], v11 offset:47104
    ds_read_b64_tr_b16 v[142:143], v11 offset:47616
    v_mfma_f32_32x32x16_bf16 v[224:239], v[172:175], v[92:95], v[224:239]
    v_mfma_f32_32x32x16_bf16 v[224:239], v[176:179], v[96:99], v[224:239]
    v_mfma_f32_32x32x16_bf16 v[224:239], v[180:183], v[100:103], v[224:239]
    v_mfma_f32_32x32x16_bf16 v[224:239], v[184:187], v[104:107], v[224:239]
    v_mfma_f32_32x32x16_bf16 v[224:239], v[188:191], v[108:111], v[224:239]
    s_waitcnt lgkmcnt(0)
    v_mfma_f32_32x32x16_bf16 v[224:239], v[128:131], v[112:115], v[224:239]
    v_mfma_f32_32x32x16_bf16 v[224:239], v[132:135], v[116:119], v[224:239]
    v_mfma_f32_32x32x16_bf16 v[224:239], v[136:139], v[120:123], v[224:239]
    v_mfma_f32_32x32x16_bf16 v[224:239], v[140:143], v[124:127], v[224:239]
    s_mov_b64 exec, 1
    ds_add_u32 v240, v241 offset:0
    s_mov_b64 exec, -1
    s_mov_b32 s3, 0
    s_waitcnt vmcnt(4)
Lnon_1:
    v_readfirstlane_b32 s46, v243
    s_add_u32 s3, s3, 1
    s_cmp_lg_u32 s46, 0
    s_cbranch_scc1 Lnon_2
    s_cmp_gt_u32 s3, 50000
    s_cbranch_scc1 Lnon_2
    s_sleep 8
    buffer_load_dword v243, off, s[28:31], 0 sc1
    s_waitcnt vmcnt(0)
    s_branch Lnon_1
Lnon_2:
    v_mov_b32 v14, s46
    s_waitcnt vmcnt(0)
    s_mov_b64 exec, 1
    buffer_store_dword v14, off, s[4:7], s95 sc1
    s_mov_b64 exec, -1
    v_cvt_pk_bf16_f32 v224, v224, v225
    v_cvt_pk_bf16_f32 v225, v226, v227
    v_cvt_pk_bf16_f32 v226, v228, v229
    v_cvt_pk_bf16_f32 v227, v230, v231
    v_cvt_pk_bf16_f32 v228, v232, v233
    v_cvt_pk_bf16_f32 v229, v234, v235
    v_cvt_pk_bf16_f32 v230, v236, v237
    v_cvt_pk_bf16_f32 v231, v238, v239
    buffer_store_dwordx4 v[224:227], v12, s[4:7], s53 offen sc1
    buffer_store_dwordx4 v[228:231], v12, s[4:7], s53 offen offset:1024 sc1
L_attn:
    s_setprio 2
    s_mul_i32 s60, s39, 7
    s_lshr_b32 s60, s60, 1
    v_bfe_u32 v5, v0, 4, 1
    v_and_b32 v6, 15, v0
    s_lshl_b32 s61, s36, 4
    v_add_u32 v6, s61, v6
    v_bfe_u32 v7, v0, 2, 1
    v_and_b32 v1, 3, v0
    s_lshl_b32 s61, s40, 2
    v_add_u32 v1, s61, v1
    v_cmp_gt_u32 vcc, 32, v0
    s_add_u32 s61, s60, 3
    s_lshr_b32 s61, s61, 2
    v_cndmask_b32 v5, v7, v5, vcc
    v_cndmask_b32 v6, v1, v6, vcc
    s_lshr_b32 s51, s60, 2
    v_add_u32 v5, s51, v5
    v_min_u32 v5, s61, v5
    v_lshl_add_u32 v5, v5, 6, v6
    v_lshlrev_b32 v5, 7, v5
    v_add_u32 v1, 12582912, v5
    s_lshl_b32 s60, s60, 9
    v_lshlrev_b32 v2, 4, v0
    v_add_u32 v2, s60, v2
    s_add_u32 s56, s36, 1
    s_and_b32 s56, s56, 3
    s_lshl_b32 s60, s40, 2
    s_add_u32 s56, s56, s60
    s_mul_i32 s56, s56, 28672
    s_add_u32 s57, s36, 2
    s_and_b32 s57, s57, 3
    s_lshl_b32 s60, s40, 2
    s_add_u32 s57, s57, s60
    s_mul_i32 s57, s57, 28672
    s_add_u32 s58, s36, 3
    s_and_b32 s58, s58, 3
    s_lshl_b32 s60, s40, 2
    s_add_u32 s58, s58, s60
    s_mul_i32 s58, s58, 28672
    s_add_u32 s59, s36, 4
    s_and_b32 s59, s59, 3
    s_lshl_b32 s60, s40, 2
    s_add_u32 s59, s59, s60
    s_mul_i32 s59, s59, 28672
    v_and_b32 v5, 31, v0
    v_lshrrev_b32 v6, 5, v0
    v_and_b32 v3, 3, v0
    v_bfe_u32 v7, v0, 3, 1
    v_lshl_add_u32 v3, v7, 2, v3
    v_bfe_u32 v7, v0, 2, 1
    v_mad_u32_u24 v3, v7, 7, v3
    v_bfe_u32 v7, v0, 4, 1
    v_mad_u32_u24 v3, v7, 14, v3
    v_lshlrev_b32 v3, 4, v3
    v_mul_u32_u24 v7, 7168, v6
    v_add_u32 v3, v3, v7
    s_mul_i32 s60, s39, 448
    s_add_u32 s60, s60, 2097152
    v_add_u32 v3, s60, v3
    v_add_u32 v4, 14336, v3
    s_mul_i32 s50, s36, 458752
    s_add_u32 s50, s50, 2097152
    s_mov_b32 s54, 0x77ff77ff
    s_mov_b32 s55, 0x77ff77ff
    v_mov_b32 v7, 0x3f803f80
    v_or_b32 v5, 4, v5
    v_cmp_eq_u32 vcc, 31, v5
    v_mov_b32 v216, 162048
    v_mov_b32 v217, 1
    v_cndmask_b32 v7, 0, v7, vcc
    v_lshlrev_b32 v232, 4, v0
    s_add_u32 s60, s36, 1
    s_and_b32 s60, s60, 3
    s_mul_i32 s60, s60, 12288
    v_add_u32 v220, s60, v232
    s_add_u32 s60, s36, 2
    s_and_b32 s60, s60, 3
    s_mul_i32 s60, s60, 12288
    v_add_u32 v221, s60, v232
    s_add_u32 s60, s36, 3
    s_and_b32 s60, s60, 3
    s_mul_i32 s60, s60, 12288
    v_add_u32 v222, s60, v232
    s_add_u32 s60, s36, 4
    s_and_b32 s60, s60, 3
    s_mul_i32 s60, s60, 12288
    v_add_u32 v223, s60, v232
    s_lshl_b32 s52, s40, 2
    s_add_u32 s52, s52, s36
    s_lshl_b32 s52, s52, 4
    s_add_u32 s52, s52, s39
    s_lshl_b32 s52, s52, 11
    s_add_u32 s52, s52, 6160384
    v_and_b32 v233, 1, v0
    v_lshlrev_b32 v233, 4, v233
    v_lshrrev_b32 v233, v233, s46
    v_lshlrev_b32 v233, 16, v233
    s_mov_b32 s53, 0xffff
    v_mov_b32 v160, v7
    v_mov_b32 v161, v7
    v_mov_b32 v162, v7
    v_mov_b32 v163, v7
    v_mov_b32 v164, v7
    v_mov_b32 v165, v7
    v_mov_b32 v166, v7
    v_mov_b32 v167, v7
    v_mov_b32 v176, v7
    v_mov_b32 v177, v7
    v_mov_b32 v178, v7
    v_mov_b32 v179, v7
    v_mov_b32 v180, v7
    v_mov_b32 v181, v7
    v_mov_b32 v182, v7
    v_mov_b32 v183, v7
    v_mov_b32 v192, v7
    v_mov_b32 v193, v7
    v_mov_b32 v194, v7
    v_mov_b32 v195, v7
    v_mov_b32 v196, v7
    v_mov_b32 v197, v7
    v_mov_b32 v198, v7
    v_mov_b32 v199, v7
    v_mov_b32 v208, v7
    v_mov_b32 v209, v7
    v_mov_b32 v210, v7
    v_mov_b32 v211, v7
    v_mov_b32 v212, v7
    v_mov_b32 v213, v7
    v_mov_b32 v214, v7
    v_mov_b32 v215, v7
    v_mov_b32 v40, 0
    v_mov_b32 v41, 0
    v_mov_b32 v42, 0
    v_mov_b32 v43, 0
    v_mov_b32 v44, 0
    v_mov_b32 v45, 0
    v_mov_b32 v46, 0
    v_mov_b32 v47, 0
    v_mov_b32 v48, 0
    v_mov_b32 v49, 0
    v_mov_b32 v50, 0
    v_mov_b32 v51, 0
    v_mov_b32 v52, 0
    v_mov_b32 v53, 0
    v_mov_b32 v54, 0
    v_mov_b32 v55, 0
    v_mov_b32 v56, 0
    v_mov_b32 v57, 0
    v_mov_b32 v58, 0
    v_mov_b32 v59, 0
    v_mov_b32 v60, 0
    v_mov_b32 v61, 0
    v_mov_b32 v62, 0
    v_mov_b32 v63, 0
    v_mov_b32 v64, 0
    v_mov_b32 v65, 0
    v_mov_b32 v66, 0
    v_mov_b32 v67, 0
    v_mov_b32 v68, 0
    v_mov_b32 v69, 0
    v_mov_b32 v70, 0
    v_mov_b32 v71, 0
    v_mov_b32 v72, 0
    v_mov_b32 v73, 0
    v_mov_b32 v74, 0
    v_mov_b32 v75, 0
    v_mov_b32 v76, 0
    v_mov_b32 v77, 0
    v_mov_b32 v78, 0
    v_mov_b32 v79, 0
    v_mov_b32 v80, 0
    v_mov_b32 v81, 0
    v_mov_b32 v82, 0
    v_mov_b32 v83, 0
    v_mov_b32 v84, 0
    v_mov_b32 v85, 0
    v_mov_b32 v86, 0
    v_mov_b32 v87, 0
    v_mov_b32 v88, 0
    v_mov_b32 v89, 0
    v_mov_b32 v90, 0
    v_mov_b32 v91, 0
    v_mov_b32 v92, 0
    v_mov_b32 v93, 0
    v_mov_b32 v94, 0
    v_mov_b32 v95, 0
    v_mov_b32 v96, 0
    v_mov_b32 v97, 0
    v_mov_b32 v98, 0
    v_mov_b32 v99, 0
    v_mov_b32 v100, 0
    v_mov_b32 v101, 0
    v_mov_b32 v102, 0
    v_mov_b32 v103, 0
    v_mov_b32 v144, 0
    v_mov_b32 v145, 0
    v_mov_b32 v146, 0
    v_mov_b32 v147, 0
    v_mov_b32 v148, 0
    v_mov_b32 v149, 0
    v_mov_b32 v150, 0
    v_mov_b32 v151, 0
    v_mov_b32 v132, 0
    v_mov_b32 v133, 0
    v_mov_b32 v134, 0
    v_mov_b32 v135, 0
    s_mov_b32 exec_hi, 0xff
    buffer_load_dword v219, v1, s[4:7], 0 offen sc1
    s_mov_b64 exec, -1
    s_mov_b32 exec_hi, 0xff
    s_waitcnt vmcnt(0)
    v_cmp_ne_u32 vcc, s46, v219
    s_mov_b64 exec, -1
    s_cbranch_vccz L_go
    s_setprio 0
    s_mov_b32 exec_hi, 0xff
    s_mov_b32 s3, 0
Lpoll_3:
    buffer_load_dword v5, v1, s[4:7], 0 offen sc1
    s_add_u32 s3, s3, 1
    s_cmp_gt_u32 s3, 50000
    s_cbranch_scc1 Lpoll_4
    s_waitcnt vmcnt(0)
    v_cmp_ne_u32 vcc, s46, v5
    s_cbranch_vccz Lpoll_4
    s_mov_b64 exec, vcc
    s_bcnt1_i32_b64 s63, vcc
    s_cmp_le_u32 s63, 8
    s_cbranch_scc1 Lpoll_3
    s_sleep 6
    s_branch Lpoll_3
Lpoll_4:
    s_mov_b64 exec, -1
L_go:
    s_setprio 2
    buffer_load_dwordx4 v[8:11], v2, s[4:7], s56 offen sc1
    buffer_load_dwordx4 v[12:15], v2, s[4:7], s56 offen offset:1024 sc1
    buffer_load_dwordx4 v[152:155], v2, s[4:7], s50 offen sc1
    buffer_load_dwordx4 v[156:159], v2, s[4:7], s50 offen offset:1024 sc1
    buffer_load_dwordx4 v[16:19], v2, s[4:7], s57 offen sc1
    buffer_load_dwordx4 v[20:23], v2, s[4:7], s57 offen offset:1024 sc1
    buffer_load_dwordx4 v[24:27], v2, s[4:7], s58 offen sc1
    buffer_load_dwordx4 v[28:31], v2, s[4:7], s58 offen offset:1024 sc1
    buffer_load_dwordx4 v[32:35], v2, s[4:7], s59 offen sc1
    buffer_load_dwordx4 v[36:39], v2, s[4:7], s59 offen offset:1024 sc1
    s_mov_b64 exec, s[54:55]
    buffer_load_dwordx4 v[160:163], v3, s[4:7], s50 offen sc1
    buffer_load_dwordx4 v[164:167], v4, s[4:7], s50 offen sc1
    s_mov_b64 exec, -1
    s_add_u32 s50, s50, 28672
    buffer_load_dwordx4 v[168:171], v2, s[4:7], s50 offen sc1
    buffer_load_dwordx4 v[172:175], v2, s[4:7], s50 offen offset:1024 sc1
    s_mov_b64 exec, s[54:55]
    buffer_load_dwordx4 v[176:179], v3, s[4:7], s50 offen sc1
    buffer_load_dwordx4 v[180:183], v4, s[4:7], s50 offen sc1
    s_mov_b64 exec, -1
    s_add_u32 s50, s50, 28672
    buffer_load_dwordx4 v[184:187], v2, s[4:7], s50 offen sc1
    buffer_load_dwordx4 v[188:191], v2, s[4:7], s50 offen offset:1024 sc1
    s_mov_b64 exec, s[54:55]
    buffer_load_dwordx4 v[192:195], v3, s[4:7], s50 offen sc1
    buffer_load_dwordx4 v[196:199], v4, s[4:7], s50 offen sc1
    s_mov_b64 exec, -1
    s_add_u32 s50, s50, 28672
    buffer_load_dwordx4 v[200:203], v2, s[4:7], s50 offen sc1
    buffer_load_dwordx4 v[204:207], v2, s[4:7], s50 offen offset:1024 sc1
    s_mov_b32 s3, 0
    s_waitcnt vmcnt(20)
Lqv_7:
    v_max_u32 v219, v8, v9
    v_max3_u32 v219, v10, v11, v219
    v_max3_u32 v219, v12, v13, v219
    v_max3_u32 v219, v14, v15, v219
    v_cmp_eq_u32 vcc, -1, v219
    s_cbranch_vccnz Lqr_8
Lqr_8_b:
    s_bitcmp0_b32 s39, 0
    s_waitcnt vmcnt(20)
    s_cbranch_scc1 Lqz_5
    s_mov_b32 exec_hi, 0
    v_mov_b32 v8, 0
    v_mov_b32 v9, 0
    s_branch Lqz_6
Lqz_5:
    s_mov_b32 exec_lo, 0
    v_mov_b32 v14, 0
    v_mov_b32 v15, 0
Lqz_6:
    s_mov_b64 exec, -1
    s_waitcnt vmcnt(18)
    s_mov_b32 s51, 0
    s_nop 1
    v_mfma_f32_32x32x16_bf16 v[104:119], v[152:155], v[8:11], 0
    v_mfma_f32_32x32x16_bf16 v[104:119], v[156:159], v[12:15], v[104:119]
    s_mov_b32 s3, 0
    s_waitcnt vmcnt(12)
Lqv_11:
    v_max_u32 v219, v16, v17
    v_max3_u32 v219, v18, v19, v219
    v_max3_u32 v219, v20, v21, v219
    v_max3_u32 v219, v22, v23, v219
    v_max3_u32 v219, v24, v25, v219
    v_max3_u32 v219, v26, v27, v219
    v_max3_u32 v219, v28, v29, v219
    v_max3_u32 v219, v30, v31, v219
    v_max3_u32 v219, v32, v33, v219
    v_max3_u32 v219, v34, v35, v219
    v_max3_u32 v219, v36, v37, v219
    v_max3_u32 v219, v38, v39, v219
    v_cmp_eq_u32 vcc, -1, v219
    s_cbranch_vccnz Lqr_12
Lqr_12_b:
    s_bitcmp0_b32 s39, 0
    s_waitcnt vmcnt(12)
    s_cbranch_scc1 Lqz_9
    s_mov_b32 exec_hi, 0
    v_mov_b32 v16, 0
    v_mov_b32 v17, 0
    v_mov_b32 v24, 0
    v_mov_b32 v25, 0
    v_mov_b32 v32, 0
    v_mov_b32 v33, 0
    s_branch Lqz_10
Lqz_9:
    s_mov_b32 exec_lo, 0
    v_mov_b32 v22, 0
    v_mov_b32 v23, 0
    v_mov_b32 v30, 0
    v_mov_b32 v31, 0
    v_mov_b32 v38, 0
    v_mov_b32 v39, 0
Lqz_10:
    s_mov_b64 exec, -1
    s_nop 3
    .p2align 6
Lattn_13:
    v_mfma_f32_32x32x16_bf16 v[88:103], v[208:211], v[144:147], v[88:103]
    v_cvt_pk_bf16_f32 v150, v132, v133
    v_cvt_pk_bf16_f32 v151, v134, v135
    v_exp_f32 v104, v104
    v_exp_f32 v105, v105
    v_exp_f32 v106, v106
    v_exp_f32 v107, v107
    v_mfma_f32_32x32x16_bf16 v[120:135], v[152:155], v[16:19], 0
    v_cvt_pk_bf16_f32 v136, v104, v105
    v_cvt_pk_bf16_f32 v137, v106, v107
    v_exp_f32 v108, v108
    v_exp_f32 v109, v109
    v_exp_f32 v110, v110
    v_exp_f32 v111, v111
    v_mfma_f32_32x32x16_bf16 v[120:135], v[156:159], v[20:23], v[120:135]
    v_cvt_pk_bf16_f32 v138, v108, v109
    v_cvt_pk_bf16_f32 v139, v110, v111
    v_exp_f32 v112, v112
    v_exp_f32 v113, v113
    v_exp_f32 v114, v114
    v_exp_f32 v115, v115
    v_mfma_f32_32x32x16_bf16 v[88:103], v[212:215], v[148:151], v[88:103]
    v_cvt_pk_bf16_f32 v140, v112, v113
    v_cvt_pk_bf16_f32 v141, v114, v115
    v_exp_f32 v116, v116
    v_exp_f32 v117, v117
    v_exp_f32 v118, v118
    s_waitcnt vmcnt(10)
    v_exp_f32 v119, v119
    v_mfma_f32_32x32x16_bf16 v[40:55], v[160:163], v[136:139], v[40:55]
    v_cvt_pk_bf16_f32 v142, v116, v117
    v_cvt_pk_bf16_f32 v143, v118, v119
    v_exp_f32 v120, v120
    v_exp_f32 v121, v121
    v_exp_f32 v122, v122
    v_exp_f32 v123, v123
    v_mfma_f32_32x32x16_bf16 v[104:119], v[152:155], v[24:27], 0
    s_mov_b64 exec, s[54:55]
    buffer_load_dwordx4 v[208:211], v3, s[4:7], s50 offen sc1
    buffer_load_dwordx4 v[212:215], v4, s[4:7], s50 offen sc1
    s_mov_b64 exec, -1
    v_cvt_pk_bf16_f32 v144, v120, v121
    v_cvt_pk_bf16_f32 v145, v122, v123
    v_exp_f32 v124, v124
    v_exp_f32 v125, v125
    v_exp_f32 v126, v126
    v_exp_f32 v127, v127
    v_mfma_f32_32x32x16_bf16 v[104:119], v[156:159], v[28:31], v[104:119]
    v_cvt_pk_bf16_f32 v146, v124, v125
    v_cvt_pk_bf16_f32 v147, v126, v127
    v_exp_f32 v128, v128
    v_exp_f32 v129, v129
    v_exp_f32 v130, v130
    v_exp_f32 v131, v131
    v_mfma_f32_32x32x16_bf16 v[40:55], v[164:167], v[140:143], v[40:55]
    v_cvt_pk_bf16_f32 v148, v128, v129
    v_cvt_pk_bf16_f32 v149, v130, v131
    v_exp_f32 v132, v132
    v_exp_f32 v133, v133
    v_exp_f32 v134, v134
    v_exp_f32 v135, v135
    v_mfma_f32_32x32x16_bf16 v[56:71], v[160:163], v[144:147], v[56:71]
    v_cvt_pk_bf16_f32 v150, v132, v133
    v_cvt_pk_bf16_f32 v151, v134, v135
    v_exp_f32 v104, v104
    v_exp_f32 v105, v105
    v_exp_f32 v106, v106
    v_exp_f32 v107, v107
    v_mfma_f32_32x32x16_bf16 v[120:135], v[152:155], v[32:35], 0
    v_cvt_pk_bf16_f32 v136, v104, v105
    v_cvt_pk_bf16_f32 v137, v106, v107
    v_exp_f32 v108, v108
    v_exp_f32 v109, v109
    v_exp_f32 v110, v110
    v_exp_f32 v111, v111
    v_mfma_f32_32x32x16_bf16 v[120:135], v[156:159], v[36:39], v[120:135]
    v_cvt_pk_bf16_f32 v138, v108, v109
    v_cvt_pk_bf16_f32 v139, v110, v111
    v_exp_f32 v112, v112
    v_exp_f32 v113, v113
    v_exp_f32 v114, v114
    v_exp_f32 v115, v115
    v_mfma_f32_32x32x16_bf16 v[56:71], v[164:167], v[148:151], v[56:71]
    v_cvt_pk_bf16_f32 v140, v112, v113
    v_cvt_pk_bf16_f32 v141, v114, v115
    v_exp_f32 v116, v116
    v_exp_f32 v117, v117
    v_exp_f32 v118, v118
    v_exp_f32 v119, v119
    v_mfma_f32_32x32x16_bf16 v[72:87], v[160:163], v[136:139], v[72:87]
    v_cvt_pk_bf16_f32 v142, v116, v117
    v_cvt_pk_bf16_f32 v143, v118, v119
    v_exp_f32 v120, v120
    v_exp_f32 v121, v121
    s_add_u32 s50, s50, 28672
    v_exp_f32 v122, v122
    s_waitcnt vmcnt(10)
    v_exp_f32 v123, v123
    v_mfma_f32_32x32x16_bf16 v[104:119], v[168:171], v[8:11], 0
    v_cvt_pk_bf16_f32 v144, v120, v121
    v_cvt_pk_bf16_f32 v145, v122, v123
    v_exp_f32 v124, v124
    v_exp_f32 v125, v125
    v_exp_f32 v126, v126
    v_exp_f32 v127, v127
    v_mfma_f32_32x32x16_bf16 v[104:119], v[172:175], v[12:15], v[104:119]
    buffer_load_dwordx4 v[152:155], v2, s[4:7], s50 offen sc1
    v_cvt_pk_bf16_f32 v146, v124, v125
    v_cvt_pk_bf16_f32 v147, v126, v127
    v_exp_f32 v128, v128
    v_exp_f32 v129, v129
    v_exp_f32 v130, v130
    v_exp_f32 v131, v131
    v_mfma_f32_32x32x16_bf16 v[72:87], v[164:167], v[140:143], v[72:87]
    buffer_load_dwordx4 v[156:159], v2, s[4:7], s50 offen offset:1024 sc1
    v_cvt_pk_bf16_f32 v148, v128, v129
    v_cvt_pk_bf16_f32 v149, v130, v131
    v_exp_f32 v132, v132
    v_exp_f32 v133, v133
    v_exp_f32 v134, v134
    v_exp_f32 v135, v135
    v_mfma_f32_32x32x16_bf16 v[88:103], v[160:163], v[144:147], v[88:103]
    v_cvt_pk_bf16_f32 v150, v132, v133
    v_cvt_pk_bf16_f32 v151, v134, v135
    v_exp_f32 v104, v104
    v_exp_f32 v105, v105
    v_exp_f32 v106, v106
    v_exp_f32 v107, v107
    v_mfma_f32_32x32x16_bf16 v[120:135], v[168:171], v[16:19], 0
    v_cvt_pk_bf16_f32 v136, v104, v105
    v_cvt_pk_bf16_f32 v137, v106, v107
    v_exp_f32 v108, v108
    v_exp_f32 v109, v109
    v_exp_f32 v110, v110
    v_exp_f32 v111, v111
    v_mfma_f32_32x32x16_bf16 v[120:135], v[172:175], v[20:23], v[120:135]
    v_cvt_pk_bf16_f32 v138, v108, v109
    v_cvt_pk_bf16_f32 v139, v110, v111
    v_exp_f32 v112, v112
    v_exp_f32 v113, v113
    v_exp_f32 v114, v114
    v_exp_f32 v115, v115
    v_mfma_f32_32x32x16_bf16 v[88:103], v[164:167], v[148:151], v[88:103]
    v_cvt_pk_bf16_f32 v140, v112, v113
    v_cvt_pk_bf16_f32 v141, v114, v115
    v_exp_f32 v116, v116
    v_exp_f32 v117, v117
    v_exp_f32 v118, v118
    s_waitcnt vmcnt(10)
    v_exp_f32 v119, v119
    v_mfma_f32_32x32x16_bf16 v[40:55], v[176:179], v[136:139], v[40:55]
    v_cvt_pk_bf16_f32 v142, v116, v117
    v_cvt_pk_bf16_f32 v143, v118, v119
    v_exp_f32 v120, v120
    v_exp_f32 v121, v121
    v_exp_f32 v122, v122
    v_exp_f32 v123, v123
    v_mfma_f32_32x32x16_bf16 v[104:119], v[168:171], v[24:27], 0
    s_mov_b64 exec, s[54:55]
    buffer_load_dwordx4 v[160:163], v3, s[4:7], s50 offen sc1
    buffer_load_dwordx4 v[164:167], v4, s[4:7], s50 offen sc1
    s_mov_b64 exec, -1
    v_cvt_pk_bf16_f32 v144, v120, v121
    v_cvt_pk_bf16_f32 v145, v122, v123
    v_exp_f32 v124, v124
    v_exp_f32 v125, v125
    v_exp_f32 v126, v126
    v_exp_f32 v127, v127
    v_mfma_f32_32x32x16_bf16 v[104:119], v[172:175], v[28:31], v[104:119]
    v_cvt_pk_bf16_f32 v146, v124, v125
    v_cvt_pk_bf16_f32 v147, v126, v127
    v_exp_f32 v128, v128
    v_exp_f32 v129, v129
    v_exp_f32 v130, v130
    v_exp_f32 v131, v131
    v_mfma_f32_32x32x16_bf16 v[40:55], v[180:183], v[140:143], v[40:55]
    v_cvt_pk_bf16_f32 v148, v128, v129
    v_cvt_pk_bf16_f32 v149, v130, v131
    v_exp_f32 v132, v132
    v_exp_f32 v133, v133
    v_exp_f32 v134, v134
    v_exp_f32 v135, v135
    v_mfma_f32_32x32x16_bf16 v[56:71], v[176:179], v[144:147], v[56:71]
    v_cvt_pk_bf16_f32 v150, v132, v133
    v_cvt_pk_bf16_f32 v151, v134, v135
    v_exp_f32 v104, v104
    v_exp_f32 v105, v105
    v_exp_f32 v106, v106
    v_exp_f32 v107, v107
    v_mfma_f32_32x32x16_bf16 v[120:135], v[168:171], v[32:35], 0
    v_cvt_pk_bf16_f32 v136, v104, v105
    v_cvt_pk_bf16_f32 v137, v106, v107
    v_exp_f32 v108, v108
    v_exp_f32 v109, v109
    v_exp_f32 v110, v110
    v_exp_f32 v111, v111
    v_mfma_f32_32x32x16_bf16 v[120:135], v[172:175], v[36:39], v[120:135]
    v_cvt_pk_bf16_f32 v138, v108, v109
    v_cvt_pk_bf16_f32 v139, v110, v111
    v_exp_f32 v112, v112
    v_exp_f32 v113, v113
    v_exp_f32 v114, v114
    v_exp_f32 v115, v115
    v_mfma_f32_32x32x16_bf16 v[56:71], v[180:183], v[148:151], v[56:71]
    v_cvt_pk_bf16_f32 v140, v112, v113
    v_cvt_pk_bf16_f32 v141, v114, v115
    v_exp_f32 v116, v116
    v_exp_f32 v117, v117
    v_exp_f32 v118, v118
    v_exp_f32 v119, v119
    v_mfma_f32_32x32x16_bf16 v[72:87], v[176:179], v[136:139], v[72:87]
    v_cvt_pk_bf16_f32 v142, v116, v117
    v_cvt_pk_bf16_f32 v143, v118, v119
    v_exp_f32 v120, v120
    v_exp_f32 v121, v121
    s_add_u32 s50, s50, 28672
    v_exp_f32 v122, v122
    s_waitcnt vmcnt(10)
    v_exp_f32 v123, v123
    v_mfma_f32_32x32x16_bf16 v[104:119], v[184:187], v[8:11], 0
    v_cvt_pk_bf16_f32 v144, v120, v121
    v_cvt_pk_bf16_f32 v145, v122, v123
    v_exp_f32 v124, v124
    v_exp_f32 v125, v125
    v_exp_f32 v126, v126
    v_exp_f32 v127, v127
    v_mfma_f32_32x32x16_bf16 v[104:119], v[188:191], v[12:15], v[104:119]
    buffer_load_dwordx4 v[168:171], v2, s[4:7], s50 offen sc1
    v_cvt_pk_bf16_f32 v146, v124, v125
    v_cvt_pk_bf16_f32 v147, v126, v127
    v_exp_f32 v128, v128
    v_exp_f32 v129, v129
    v_exp_f32 v130, v130
    v_exp_f32 v131, v131
    v_mfma_f32_32x32x16_bf16 v[72:87], v[180:183], v[140:143], v[72:87]
    buffer_load_dwordx4 v[172:175], v2, s[4:7], s50 offen offset:1024 sc1
    v_cvt_pk_bf16_f32 v148, v128, v129
    v_cvt_pk_bf16_f32 v149, v130, v131
    v_exp_f32 v132, v132
    v_exp_f32 v133, v133
    v_exp_f32 v134, v134
    v_exp_f32 v135, v135
    v_mfma_f32_32x32x16_bf16 v[88:103], v[176:179], v[144:147], v[88:103]
    v_cvt_pk_bf16_f32 v150, v132, v133
    v_cvt_pk_bf16_f32 v151, v134, v135
    v_exp_f32 v104, v104
    v_exp_f32 v105, v105
    v_exp_f32 v106, v106
    v_exp_f32 v107, v107
    v_mfma_f32_32x32x16_bf16 v[120:135], v[184:187], v[16:19], 0
    v_cvt_pk_bf16_f32 v136, v104, v105
    v_cvt_pk_bf16_f32 v137, v106, v107
    v_exp_f32 v108, v108
    v_exp_f32 v109, v109
    v_exp_f32 v110, v110
    v_exp_f32 v111, v111
    v_mfma_f32_32x32x16_bf16 v[120:135], v[188:191], v[20:23], v[120:135]
    v_cvt_pk_bf16_f32 v138, v108, v109
    v_cvt_pk_bf16_f32 v139, v110, v111
    v_exp_f32 v112, v112
    v_exp_f32 v113, v113
    v_exp_f32 v114, v114
    v_exp_f32 v115, v115
    v_mfma_f32_32x32x16_bf16 v[88:103], v[180:183], v[148:151], v[88:103]
    v_cvt_pk_bf16_f32 v140, v112, v113
    v_cvt_pk_bf16_f32 v141, v114, v115
    v_exp_f32 v116, v116
    v_exp_f32 v117, v117
    v_exp_f32 v118, v118
    s_waitcnt vmcnt(10)
    v_exp_f32 v119, v119
    v_mfma_f32_32x32x16_bf16 v[40:55], v[192:195], v[136:139], v[40:55]
    v_cvt_pk_bf16_f32 v142, v116, v117
    v_cvt_pk_bf16_f32 v143, v118, v119
    v_exp_f32 v120, v120
    v_exp_f32 v121, v121
    v_exp_f32 v122, v122
    v_exp_f32 v123, v123
    v_mfma_f32_32x32x16_bf16 v[104:119], v[184:187], v[24:27], 0
    s_mov_b64 exec, s[54:55]
    buffer_load_dwordx4 v[176:179], v3, s[4:7], s50 offen sc1
    buffer_load_dwordx4 v[180:183], v4, s[4:7], s50 offen sc1
    s_mov_b64 exec, -1
    v_cvt_pk_bf16_f32 v144, v120, v121
    v_cvt_pk_bf16_f32 v145, v122, v123
    v_exp_f32 v124, v124
    v_exp_f32 v125, v125
    v_exp_f32 v126, v126
    v_exp_f32 v127, v127
    v_mfma_f32_32x32x16_bf16 v[104:119], v[188:191], v[28:31], v[104:119]
    v_cvt_pk_bf16_f32 v146, v124, v125
    v_cvt_pk_bf16_f32 v147, v126, v127
    v_exp_f32 v128, v128
    v_exp_f32 v129, v129
    v_exp_f32 v130, v130
    v_exp_f32 v131, v131
    v_mfma_f32_32x32x16_bf16 v[40:55], v[196:199], v[140:143], v[40:55]
    v_cvt_pk_bf16_f32 v148, v128, v129
    v_cvt_pk_bf16_f32 v149, v130, v131
    v_exp_f32 v132, v132
    v_exp_f32 v133, v133
    v_exp_f32 v134, v134
    v_exp_f32 v135, v135
    v_mfma_f32_32x32x16_bf16 v[56:71], v[192:195], v[144:147], v[56:71]
    v_cvt_pk_bf16_f32 v150, v132, v133
    v_cvt_pk_bf16_f32 v151, v134, v135
    v_exp_f32 v104, v104
    v_exp_f32 v105, v105
    v_exp_f32 v106, v106
    v_exp_f32 v107, v107
    v_mfma_f32_32x32x16_bf16 v[120:135], v[184:187], v[32:35], 0
    v_cvt_pk_bf16_f32 v136, v104, v105
    v_cvt_pk_bf16_f32 v137, v106, v107
    v_exp_f32 v108, v108
    v_exp_f32 v109, v109
    v_exp_f32 v110, v110
    v_exp_f32 v111, v111
    v_mfma_f32_32x32x16_bf16 v[120:135], v[188:191], v[36:39], v[120:135]
    v_cvt_pk_bf16_f32 v138, v108, v109
    v_cvt_pk_bf16_f32 v139, v110, v111
    v_exp_f32 v112, v112
    v_exp_f32 v113, v113
    v_exp_f32 v114, v114
    v_exp_f32 v115, v115
    v_mfma_f32_32x32x16_bf16 v[56:71], v[196:199], v[148:151], v[56:71]
    v_cvt_pk_bf16_f32 v140, v112, v113
    v_cvt_pk_bf16_f32 v141, v114, v115
    v_exp_f32 v116, v116
    v_exp_f32 v117, v117
    v_exp_f32 v118, v118
    v_exp_f32 v119, v119
    v_mfma_f32_32x32x16_bf16 v[72:87], v[192:195], v[136:139], v[72:87]
    v_cvt_pk_bf16_f32 v142, v116, v117
    v_cvt_pk_bf16_f32 v143, v118, v119
    v_exp_f32 v120, v120
    v_exp_f32 v121, v121
    s_add_u32 s50, s50, 28672
    v_exp_f32 v122, v122
    s_waitcnt vmcnt(10)
    v_exp_f32 v123, v123
    v_mfma_f32_32x32x16_bf16 v[104:119], v[200:203], v[8:11], 0
    v_cvt_pk_bf16_f32 v144, v120, v121
    v_cvt_pk_bf16_f32 v145, v122, v123
    v_exp_f32 v124, v124
    v_exp_f32 v125, v125
    v_exp_f32 v126, v126
    v_exp_f32 v127, v127
    v_mfma_f32_32x32x16_bf16 v[104:119], v[204:207], v[12:15], v[104:119]
    buffer_load_dwordx4 v[184:187], v2, s[4:7], s50 offen sc1
    v_cvt_pk_bf16_f32 v146, v124, v125
    v_cvt_pk_bf16_f32 v147, v126, v127
    v_exp_f32 v128, v128
    v_exp_f32 v129, v129
    v_exp_f32 v130, v130
    v_exp_f32 v131, v131
    v_mfma_f32_32x32x16_bf16 v[72:87], v[196:199], v[140:143], v[72:87]
    buffer_load_dwordx4 v[188:191], v2, s[4:7], s50 offen offset:1024 sc1
    v_cvt_pk_bf16_f32 v148, v128, v129
    v_cvt_pk_bf16_f32 v149, v130, v131
    v_exp_f32 v132, v132
    v_exp_f32 v133, v133
    v_exp_f32 v134, v134
    v_exp_f32 v135, v135
    v_mfma_f32_32x32x16_bf16 v[88:103], v[192:195], v[144:147], v[88:103]
    v_cvt_pk_bf16_f32 v150, v132, v133
    v_cvt_pk_bf16_f32 v151, v134, v135
    v_exp_f32 v104, v104
    v_exp_f32 v105, v105
    v_exp_f32 v106, v106
    v_exp_f32 v107, v107
    v_mfma_f32_32x32x16_bf16 v[120:135], v[200:203], v[16:19], 0
    v_cvt_pk_bf16_f32 v136, v104, v105
    v_cvt_pk_bf16_f32 v137, v106, v107
    v_exp_f32 v108, v108
    v_exp_f32 v109, v109
    v_exp_f32 v110, v110
    v_exp_f32 v111, v111
    v_mfma_f32_32x32x16_bf16 v[120:135], v[204:207], v[20:23], v[120:135]
    v_cvt_pk_bf16_f32 v138, v108, v109
    v_cvt_pk_bf16_f32 v139, v110, v111
    v_exp_f32 v112, v112
    v_exp_f32 v113, v113
    v_exp_f32 v114, v114
    v_exp_f32 v115, v115
    v_mfma_f32_32x32x16_bf16 v[88:103], v[196:199], v[148:151], v[88:103]
    v_cvt_pk_bf16_f32 v140, v112, v113
    v_cvt_pk_bf16_f32 v141, v114, v115
    v_exp_f32 v116, v116
    v_exp_f32 v117, v117
    v_exp_f32 v118, v118
    s_waitcnt vmcnt(10)
    v_exp_f32 v119, v119
    v_mfma_f32_32x32x16_bf16 v[40:55], v[208:211], v[136:139], v[40:55]
    v_cvt_pk_bf16_f32 v142, v116, v117
    v_cvt_pk_bf16_f32 v143, v118, v119
    v_exp_f32 v120, v120
    v_exp_f32 v121, v121
    v_exp_f32 v122, v122
    v_exp_f32 v123, v123
    v_mfma_f32_32x32x16_bf16 v[104:119], v[200:203], v[24:27], 0
    s_mov_b64 exec, s[54:55]
    buffer_load_dwordx4 v[192:195], v3, s[4:7], s50 offen sc1
    buffer_load_dwordx4 v[196:199], v4, s[4:7], s50 offen sc1
    s_mov_b64 exec, -1
    v_cvt_pk_bf16_f32 v144, v120, v121
    v_cvt_pk_bf16_f32 v145, v122, v123
    v_exp_f32 v124, v124
    v_exp_f32 v125, v125
    v_exp_f32 v126, v126
    v_exp_f32 v127, v127
    v_mfma_f32_32x32x16_bf16 v[104:119], v[204:207], v[28:31], v[104:119]
    v_cvt_pk_bf16_f32 v146, v124, v125
    v_cvt_pk_bf16_f32 v147, v126, v127
    v_exp_f32 v128, v128
    v_exp_f32 v129, v129
    v_exp_f32 v130, v130
    v_exp_f32 v131, v131
    v_mfma_f32_32x32x16_bf16 v[40:55], v[212:215], v[140:143], v[40:55]
    v_cvt_pk_bf16_f32 v148, v128, v129
    v_cvt_pk_bf16_f32 v149, v130, v131
    v_exp_f32 v132, v132
    v_exp_f32 v133, v133
    v_exp_f32 v134, v134
    v_exp_f32 v135, v135
    v_mfma_f32_32x32x16_bf16 v[56:71], v[208:211], v[144:147], v[56:71]
    v_cvt_pk_bf16_f32 v150, v132, v133
    v_cvt_pk_bf16_f32 v151, v134, v135
    v_exp_f32 v104, v104
    v_exp_f32 v105, v105
    v_exp_f32 v106, v106
    v_exp_f32 v107, v107
    v_mfma_f32_32x32x16_bf16 v[120:135], v[200:203], v[32:35], 0
    v_cvt_pk_bf16_f32 v136, v104, v105
    v_cvt_pk_bf16_f32 v137, v106, v107
    v_exp_f32 v108, v108
    v_exp_f32 v109, v109
    v_exp_f32 v110, v110
    v_exp_f32 v111, v111
    v_mfma_f32_32x32x16_bf16 v[120:135], v[204:207], v[36:39], v[120:135]
    v_cvt_pk_bf16_f32 v138, v108, v109
    v_cvt_pk_bf16_f32 v139, v110, v111
    v_exp_f32 v112, v112
    v_exp_f32 v113, v113
    v_exp_f32 v114, v114
    v_exp_f32 v115, v115
    v_mfma_f32_32x32x16_bf16 v[56:71], v[212:215], v[148:151], v[56:71]
    v_cvt_pk_bf16_f32 v140, v112, v113
    v_cvt_pk_bf16_f32 v141, v114, v115
    v_exp_f32 v116, v116
    v_exp_f32 v117, v117
    v_exp_f32 v118, v118
    v_exp_f32 v119, v119
    v_mfma_f32_32x32x16_bf16 v[72:87], v[208:211], v[136:139], v[72:87]
    v_cvt_pk_bf16_f32 v142, v116, v117
    v_cvt_pk_bf16_f32 v143, v118, v119
    v_exp_f32 v120, v120
    v_exp_f32 v121, v121
    s_add_u32 s50, s50, 28672
    v_exp_f32 v122, v122
    s_waitcnt vmcnt(10)
    v_exp_f32 v123, v123
    v_mfma_f32_32x32x16_bf16 v[104:119], v[152:155], v[8:11], 0
    v_cvt_pk_bf16_f32 v144, v120, v121
    v_cvt_pk_bf16_f32 v145, v122, v123
    v_exp_f32 v124, v124
    v_exp_f32 v125, v125
    v_exp_f32 v126, v126
    v_exp_f32 v127, v127
    v_mfma_f32_32x32x16_bf16 v[104:119], v[156:159], v[12:15], v[104:119]
    buffer_load_dwordx4 v[200:203], v2, s[4:7], s50 offen sc1
    v_cvt_pk_bf16_f32 v146, v124, v125
    v_cvt_pk_bf16_f32 v147, v126, v127
    v_exp_f32 v128, v128
    v_exp_f32 v129, v129
    s_add_u32 s51, s51, 1
    v_exp_f32 v130, v130
    s_cmp_lt_u32 s51, 3
    v_exp_f32 v131, v131
    v_mfma_f32_32x32x16_bf16 v[72:87], v[212:215], v[140:143], v[72:87]
    buffer_load_dwordx4 v[204:207], v2, s[4:7], s50 offen offset:1024 sc1
    v_cvt_pk_bf16_f32 v148, v128, v129
    v_cvt_pk_bf16_f32 v149, v130, v131
    v_exp_f32 v132, v132
    v_exp_f32 v133, v133
    v_exp_f32 v134, v134
    v_exp_f32 v135, v135
    s_cbranch_scc1 Lattn_13
    v_mfma_f32_32x32x16_bf16 v[88:103], v[208:211], v[144:147], v[88:103]
    v_cvt_pk_bf16_f32 v150, v132, v133
    v_cvt_pk_bf16_f32 v151, v134, v135
    v_exp_f32 v104, v104
    v_exp_f32 v105, v105
    v_exp_f32 v106, v106
    v_exp_f32 v107, v107
    v_mfma_f32_32x32x16_bf16 v[120:135], v[152:155], v[16:19], 0
    v_cvt_pk_bf16_f32 v136, v104, v105
    v_cvt_pk_bf16_f32 v137, v106, v107
    v_exp_f32 v108, v108
    v_exp_f32 v109, v109
    v_exp_f32 v110, v110
    v_exp_f32 v111, v111
    v_mfma_f32_32x32x16_bf16 v[120:135], v[156:159], v[20:23], v[120:135]
    v_cvt_pk_bf16_f32 v138, v108, v109
    v_cvt_pk_bf16_f32 v139, v110, v111
    v_exp_f32 v112, v112
    v_exp_f32 v113, v113
    v_exp_f32 v114, v114
    v_exp_f32 v115, v115
    v_mfma_f32_32x32x16_bf16 v[88:103], v[212:215], v[148:151], v[88:103]
    v_cvt_pk_bf16_f32 v140, v112, v113
    v_cvt_pk_bf16_f32 v141, v114, v115
    v_exp_f32 v116, v116
    v_exp_f32 v117, v117
    v_exp_f32 v118, v118
    s_waitcnt vmcnt(10)
    v_exp_f32 v119, v119
    v_mfma_f32_32x32x16_bf16 v[40:55], v[160:163], v[136:139], v[40:55]
    v_cvt_pk_bf16_f32 v142, v116, v117
    v_cvt_pk_bf16_f32 v143, v118, v119
    v_exp_f32 v120, v120
    v_exp_f32 v121, v121
    v_exp_f32 v122, v122
    v_exp_f32 v123, v123
    v_mfma_f32_32x32x16_bf16 v[104:119], v[152:155], v[24:27], 0
    s_mov_b64 exec, s[54:55]
    buffer_load_dwordx4 v[208:211], v3, s[4:7], s50 offen sc1
    buffer_load_dwordx4 v[212:215], v4, s[4:7], s50 offen sc1
    s_mov_b64 exec, -1
    v_cvt_pk_bf16_f32 v144, v120, v121
    v_cvt_pk_bf16_f32 v145, v122, v123
    v_exp_f32 v124, v124
    v_exp_f32 v125, v125
    v_exp_f32 v126, v126
    v_exp_f32 v127, v127
    v_mfma_f32_32x32x16_bf16 v[104:119], v[156:159], v[28:31], v[104:119]
    v_cvt_pk_bf16_f32 v146, v124, v125
    v_cvt_pk_bf16_f32 v147, v126, v127
    v_exp_f32 v128, v128
    v_exp_f32 v129, v129
    v_exp_f32 v130, v130
    v_exp_f32 v131, v131
    v_mfma_f32_32x32x16_bf16 v[40:55], v[164:167], v[140:143], v[40:55]
    v_cvt_pk_bf16_f32 v148, v128, v129
    v_cvt_pk_bf16_f32 v149, v130, v131
    v_exp_f32 v132, v132
    v_exp_f32 v133, v133
    v_exp_f32 v134, v134
    v_exp_f32 v135, v135
    v_mfma_f32_32x32x16_bf16 v[56:71], v[160:163], v[144:147], v[56:71]
    v_cvt_pk_bf16_f32 v150, v132, v133
    v_cvt_pk_bf16_f32 v151, v134, v135
    v_exp_f32 v104, v104
    v_exp_f32 v105, v105
    v_exp_f32 v106, v106
    v_exp_f32 v107, v107
    v_mfma_f32_32x32x16_bf16 v[120:135], v[152:155], v[32:35], 0
    v_cvt_pk_bf16_f32 v136, v104, v105
    v_cvt_pk_bf16_f32 v137, v106, v107
    v_exp_f32 v108, v108
    v_exp_f32 v109, v109
    v_exp_f32 v110, v110
    v_exp_f32 v111, v111
    v_mfma_f32_32x32x16_bf16 v[120:135], v[156:159], v[36:39], v[120:135]
    v_cvt_pk_bf16_f32 v138, v108, v109
    v_cvt_pk_bf16_f32 v139, v110, v111
    v_exp_f32 v112, v112
    v_exp_f32 v113, v113
    v_exp_f32 v114, v114
    v_exp_f32 v115, v115
    v_mfma_f32_32x32x16_bf16 v[56:71], v[164:167], v[148:151], v[56:71]
    v_cvt_pk_bf16_f32 v140, v112, v113
    v_cvt_pk_bf16_f32 v141, v114, v115
    v_exp_f32 v116, v116
    v_exp_f32 v117, v117
    v_exp_f32 v118, v118
    v_exp_f32 v119, v119
    v_mfma_f32_32x32x16_bf16 v[72:87], v[160:163], v[136:139], v[72:87]
    v_cvt_pk_bf16_f32 v142, v116, v117
    v_cvt_pk_bf16_f32 v143, v118, v119
    v_exp_f32 v120, v120
    v_exp_f32 v121, v121
    v_exp_f32 v122, v122
    s_waitcnt vmcnt(10)
    v_exp_f32 v123, v123
    v_mfma_f32_32x32x16_bf16 v[104:119], v[168:171], v[8:11], 0
    v_cvt_pk_bf16_f32 v144, v120, v121
    v_cvt_pk_bf16_f32 v145, v122, v123
    v_exp_f32 v124, v124
    v_exp_f32 v125, v125
    v_exp_f32 v126, v126
    v_exp_f32 v127, v127
    v_mfma_f32_32x32x16_bf16 v[104:119], v[172:175], v[12:15], v[104:119]
    v_cvt_pk_bf16_f32 v146, v124, v125
    v_cvt_pk_bf16_f32 v147, v126, v127
    v_exp_f32 v128, v128
    v_exp_f32 v129, v129
    v_exp_f32 v130, v130
    v_exp_f32 v131, v131
    v_mfma_f32_32x32x16_bf16 v[72:87], v[164:167], v[140:143], v[72:87]
    v_cvt_pk_bf16_f32 v148, v128, v129
    v_cvt_pk_bf16_f32 v149, v130, v131
    v_exp_f32 v132, v132
    v_exp_f32 v133, v133
    v_exp_f32 v134, v134
    v_exp_f32 v135, v135
    v_mfma_f32_32x32x16_bf16 v[88:103], v[160:163], v[144:147], v[88:103]
    v_cvt_pk_bf16_f32 v150, v132, v133
    v_cvt_pk_bf16_f32 v151, v134, v135
    v_exp_f32 v104, v104
    v_exp_f32 v105, v105
    v_exp_f32 v106, v106
    s_waitcnt vmcnt(6)
    v_exp_f32 v107, v107
    v_mfma_f32_32x32x16_bf16 v[120:135], v[184:187], v[8:11], 0
    v_cvt_pk_bf16_f32 v136, v104, v105
    v_cvt_pk_bf16_f32 v137, v106, v107
    v_exp_f32 v108, v108
    v_exp_f32 v109, v109
    v_exp_f32 v110, v110
    v_exp_f32 v111, v111
    v_mfma_f32_32x32x16_bf16 v[120:135], v[188:191], v[12:15], v[120:135]
    v_cvt_pk_bf16_f32 v138, v108, v109
    v_cvt_pk_bf16_f32 v139, v110, v111
    v_exp_f32 v112, v112
    v_exp_f32 v113, v113
    v_exp_f32 v114, v114
    v_exp_f32 v115, v115
    v_mfma_f32_32x32x16_bf16 v[88:103], v[164:167], v[148:151], v[88:103]
    v_cvt_pk_bf16_f32 v140, v112, v113
    v_cvt_pk_bf16_f32 v141, v114, v115
    v_exp_f32 v116, v116
    v_exp_f32 v117, v117
    v_exp_f32 v118, v118
    v_exp_f32 v119, v119
    v_mfma_f32_32x32x16_bf16 v[40:55], v[176:179], v[136:139], v[40:55]
    v_cvt_pk_bf16_f32 v142, v116, v117
    v_cvt_pk_bf16_f32 v143, v118, v119
    v_exp_f32 v120, v120
    v_exp_f32 v121, v121
    v_exp_f32 v122, v122
    s_waitcnt vmcnt(2)
    v_exp_f32 v123, v123
    v_mfma_f32_32x32x16_bf16 v[104:119], v[200:203], v[8:11], 0
    v_cvt_pk_bf16_f32 v144, v120, v121
    v_cvt_pk_bf16_f32 v145, v122, v123
    v_exp_f32 v124, v124
    v_exp_f32 v125, v125
    v_exp_f32 v126, v126
    v_exp_f32 v127, v127
    v_mfma_f32_32x32x16_bf16 v[104:119], v[204:207], v[12:15], v[104:119]
    s_mov_b64 exec, 1
    ds_add_u32 v216, v217 offset:48
    s_mov_b64 exec, -1
    v_cvt_pk_bf16_f32 v146, v124, v125
    v_cvt_pk_bf16_f32 v147, v126, v127
    v_exp_f32 v128, v128
    v_exp_f32 v129, v129
    v_exp_f32 v130, v130
    v_exp_f32 v131, v131
    v_mfma_f32_32x32x16_bf16 v[40:55], v[180:183], v[140:143], v[40:55]
    v_cvt_pk_bf16_f32 v148, v128, v129
    v_cvt_pk_bf16_f32 v149, v130, v131
    v_exp_f32 v132, v132
    v_exp_f32 v133, v133
    v_exp_f32 v134, v134
    v_exp_f32 v135, v135
    v_mfma_f32_32x32x16_bf16 v[40:55], v[192:195], v[144:147], v[40:55]
    v_cvt_pk_bf16_f32 v150, v132, v133
    v_cvt_pk_bf16_f32 v151, v134, v135
    v_exp_f32 v104, v104
    v_exp_f32 v105, v105
    v_exp_f32 v106, v106
    v_exp_f32 v107, v107
    v_mfma_f32_32x32x16_bf16 v[120:135], v[168:171], v[16:19], 0
    v_cvt_pk_bf16_f32 v136, v104, v105
    v_cvt_pk_bf16_f32 v137, v106, v107
    v_exp_f32 v108, v108
    v_exp_f32 v109, v109
    v_exp_f32 v110, v110
    v_exp_f32 v111, v111
    v_mfma_f32_32x32x16_bf16 v[120:135], v[172:175], v[20:23], v[120:135]
    v_cvt_pk_bf16_f32 v138, v108, v109
    v_cvt_pk_bf16_f32 v139, v110, v111
    v_exp_f32 v112, v112
    v_exp_f32 v113, v113
    v_exp_f32 v114, v114
    v_exp_f32 v115, v115
    v_mfma_f32_32x32x16_bf16 v[40:55], v[196:199], v[148:151], v[40:55]
    v_cvt_pk_bf16_f32 v140, v112, v113
    v_cvt_pk_bf16_f32 v141, v114, v115
    v_exp_f32 v116, v116
    v_exp_f32 v117, v117
    v_exp_f32 v118, v118
    s_waitcnt vmcnt(0)
    v_exp_f32 v119, v119
    v_mfma_f32_32x32x16_bf16 v[40:55], v[208:211], v[136:139], v[40:55]
    v_cvt_pk_bf16_f32 v142, v116, v117
    v_cvt_pk_bf16_f32 v143, v118, v119
    v_exp_f32 v120, v120
    v_exp_f32 v121, v121
    v_exp_f32 v122, v122
    v_exp_f32 v123, v123
    v_mfma_f32_32x32x16_bf16 v[104:119], v[184:187], v[16:19], 0
    v_cvt_pk_bf16_f32 v144, v120, v121
    v_cvt_pk_bf16_f32 v145, v122, v123
    v_exp_f32 v124, v124
    v_exp_f32 v125, v125
    v_exp_f32 v126, v126
    v_exp_f32 v127, v127
    v_mfma_f32_32x32x16_bf16 v[104:119], v[188:191], v[20:23], v[104:119]
    v_cvt_pk_bf16_f32 v146, v124, v125
    v_cvt_pk_bf16_f32 v147, v126, v127
    v_exp_f32 v128, v128
    v_exp_f32 v129, v129
    v_exp_f32 v130, v130
    v_exp_f32 v131, v131
    v_mfma_f32_32x32x16_bf16 v[40:55], v[212:215], v[140:143], v[40:55]
    v_cvt_pk_bf16_f32 v148, v128, v129
    v_cvt_pk_bf16_f32 v149, v130, v131
    v_exp_f32 v132, v132
    v_exp_f32 v133, v133
    v_exp_f32 v134, v134
    v_exp_f32 v135, v135
    v_mfma_f32_32x32x16_bf16 v[56:71], v[176:179], v[144:147], v[56:71]
    v_cvt_pk_bf16_f32 v150, v132, v133
    v_cvt_pk_bf16_f32 v151, v134, v135
    v_exp_f32 v104, v104
    v_exp_f32 v105, v105
    v_exp_f32 v106, v106
    v_exp_f32 v107, v107
    v_mfma_f32_32x32x16_bf16 v[120:135], v[200:203], v[16:19], 0
    v_cvt_pk_bf16_f32 v136, v104, v105
    v_cvt_pk_bf16_f32 v137, v106, v107
    v_exp_f32 v108, v108
    v_exp_f32 v109, v109
    v_exp_f32 v110, v110
    v_exp_f32 v111, v111
    v_mfma_f32_32x32x16_bf16 v[120:135], v[204:207], v[20:23], v[120:135]
    ds_write_b128 v220, v[40:43] offset:47360
    v_cvt_pk_bf16_f32 v138, v108, v109
    v_cvt_pk_bf16_f32 v139, v110, v111
    v_exp_f32 v112, v112
    v_exp_f32 v113, v113
    v_exp_f32 v114, v114
    v_exp_f32 v115, v115
    v_mfma_f32_32x32x16_bf16 v[56:71], v[180:183], v[148:151], v[56:71]
    ds_write_b128 v220, v[44:47] offset:48384
    v_cvt_pk_bf16_f32 v140, v112, v113
    v_cvt_pk_bf16_f32 v141, v114, v115
    v_exp_f32 v116, v116
    v_exp_f32 v117, v117
    v_exp_f32 v118, v118
    v_exp_f32 v119, v119
    v_mfma_f32_32x32x16_bf16 v[56:71], v[192:195], v[136:139], v[56:71]
    v_cvt_pk_bf16_f32 v142, v116, v117
    v_cvt_pk_bf16_f32 v143, v118, v119
    v_exp_f32 v120, v120
    v_exp_f32 v121, v121
    v_exp_f32 v122, v122
    v_exp_f32 v123, v123
    v_mfma_f32_32x32x16_bf16 v[104:119], v[168:171], v[24:27], 0
    ds_write_b128 v220, v[48:51] offset:49408
    v_cvt_pk_bf16_f32 v144, v120, v121
    v_cvt_pk_bf16_f32 v145, v122, v123
    v_exp_f32 v124, v124
    v_exp_f32 v125, v125
    v_exp_f32 v126, v126
    v_exp_f32 v127, v127
    v_mfma_f32_32x32x16_bf16 v[104:119], v[172:175], v[28:31], v[104:119]
    v_cvt_pk_bf16_f32 v146, v124, v125
    v_cvt_pk_bf16_f32 v147, v126, v127
    v_exp_f32 v128, v128
    v_exp_f32 v129, v129
    v_exp_f32 v130, v130
    v_exp_f32 v131, v131
    v_mfma_f32_32x32x16_bf16 v[56:71], v[196:199], v[140:143], v[56:71]
    ds_write_b128 v220, v[52:55] offset:50432
    v_cvt_pk_bf16_f32 v148, v128, v129
    v_cvt_pk_bf16_f32 v149, v130, v131
    v_exp_f32 v132, v132
    v_exp_f32 v133, v133
    v_exp_f32 v134, v134
    v_exp_f32 v135, v135
    v_mfma_f32_32x32x16_bf16 v[56:71], v[208:211], v[144:147], v[56:71]
    v_cvt_pk_bf16_f32 v150, v132, v133
    v_cvt_pk_bf16_f32 v151, v134, v135
    v_exp_f32 v104, v104
    v_exp_f32 v105, v105
    v_exp_f32 v106, v106
    v_exp_f32 v107, v107
    v_mfma_f32_32x32x16_bf16 v[120:135], v[184:187], v[24:27], 0
    v_cvt_pk_bf16_f32 v136, v104, v105
    v_cvt_pk_bf16_f32 v137, v106, v107
    v_exp_f32 v108, v108
    v_exp_f32 v109, v109
    v_exp_f32 v110, v110
    v_exp_f32 v111, v111
    v_mfma_f32_32x32x16_bf16 v[120:135], v[188:191], v[28:31], v[120:135]
    v_cvt_pk_bf16_f32 v138, v108, v109
    v_cvt_pk_bf16_f32 v139, v110, v111
    v_exp_f32 v112, v112
    v_exp_f32 v113, v113
    v_exp_f32 v114, v114
    v_exp_f32 v115, v115
    v_mfma_f32_32x32x16_bf16 v[56:71], v[212:215], v[148:151], v[56:71]
    v_cvt_pk_bf16_f32 v140, v112, v113
    v_cvt_pk_bf16_f32 v141, v114, v115
    v_exp_f32 v116, v116
    v_exp_f32 v117, v117
    v_exp_f32 v118, v118
    v_exp_f32 v119, v119
    v_mfma_f32_32x32x16_bf16 v[72:87], v[176:179], v[136:139], v[72:87]
    v_cvt_pk_bf16_f32 v142, v116, v117
    v_cvt_pk_bf16_f32 v143, v118, v119
    v_exp_f32 v120, v120
    v_exp_f32 v121, v121
    v_exp_f32 v122, v122
    v_exp_f32 v123, v123
    v_mfma_f32_32x32x16_bf16 v[104:119], v[200:203], v[24:27], 0
    v_cvt_pk_bf16_f32 v144, v120, v121
    v_cvt_pk_bf16_f32 v145, v122, v123
    v_exp_f32 v124, v124
    v_exp_f32 v125, v125
    v_exp_f32 v126, v126
    v_exp_f32 v127, v127
    v_mfma_f32_32x32x16_bf16 v[104:119], v[204:207], v[28:31], v[104:119]
    ds_write_b128 v221, v[56:59] offset:51456
    v_cvt_pk_bf16_f32 v146, v124, v125
    v_cvt_pk_bf16_f32 v147, v126, v127
    v_exp_f32 v128, v128
    v_exp_f32 v129, v129
    v_exp_f32 v130, v130
    v_exp_f32 v131, v131
    v_mfma_f32_32x32x16_bf16 v[72:87], v[180:183], v[140:143], v[72:87]
    ds_write_b128 v221, v[60:63] offset:52480
    v_cvt_pk_bf16_f32 v148, v128, v129
    v_cvt_pk_bf16_f32 v149, v130, v131
    v_exp_f32 v132, v132
    v_exp_f32 v133, v133
    v_exp_f32 v134, v134
    v_exp_f32 v135, v135
    v_mfma_f32_32x32x16_bf16 v[72:87], v[192:195], v[144:147], v[72:87]
    v_cvt_pk_bf16_f32 v150, v132, v133
    v_cvt_pk_bf16_f32 v151, v134, v135
    v_exp_f32 v104, v104
    v_exp_f32 v105, v105
    v_exp_f32 v106, v106
    v_exp_f32 v107, v107
    v_mfma_f32_32x32x16_bf16 v[120:135], v[168:171], v[32:35], 0
    ds_write_b128 v221, v[64:67] offset:53504
    v_cvt_pk_bf16_f32 v136, v104, v105
    v_cvt_pk_bf16_f32 v137, v106, v107
    v_exp_f32 v108, v108
    v_exp_f32 v109, v109
    v_exp_f32 v110, v110
    v_exp_f32 v111, v111
    v_mfma_f32_32x32x16_bf16 v[120:135], v[172:175], v[36:39], v[120:135]
    v_cvt_pk_bf16_f32 v138, v108, v109
    v_cvt_pk_bf16_f32 v139, v110, v111
    v_exp_f32 v112, v112
    v_exp_f32 v113, v113
    v_exp_f32 v114, v114
    v_exp_f32 v115, v115
    v_mfma_f32_32x32x16_bf16 v[72:87], v[196:199], v[148:151], v[72:87]
    ds_write_b128 v221, v[68:71] offset:54528
    v_cvt_pk_bf16_f32 v140, v112, v113
    v_cvt_pk_bf16_f32 v141, v114, v115
    v_exp_f32 v116, v116
    v_exp_f32 v117, v117
    v_exp_f32 v118, v118
    v_exp_f32 v119, v119
    v_mfma_f32_32x32x16_bf16 v[72:87], v[208:211], v[136:139], v[72:87]
    v_cvt_pk_bf16_f32 v142, v116, v117
    v_cvt_pk_bf16_f32 v143, v118, v119
    v_exp_f32 v120, v120
    v_exp_f32 v121, v121
    v_exp_f32 v122, v122
    v_exp_f32 v123, v123
    v_mfma_f32_32x32x16_bf16 v[104:119], v[184:187], v[32:35], 0
    v_cvt_pk_bf16_f32 v144, v120, v121
    v_cvt_pk_bf16_f32 v145, v122, v123
    v_exp_f32 v124, v124
    v_exp_f32 v125, v125
    v_exp_f32 v126, v126
    v_exp_f32 v127, v127
    v_mfma_f32_32x32x16_bf16 v[104:119], v[188:191], v[36:39], v[104:119]
    v_cvt_pk_bf16_f32 v146, v124, v125
    v_cvt_pk_bf16_f32 v147, v126, v127
    v_exp_f32 v128, v128
    v_exp_f32 v129, v129
    v_exp_f32 v130, v130
    v_exp_f32 v131, v131
    v_mfma_f32_32x32x16_bf16 v[72:87], v[212:215], v[140:143], v[72:87]
    v_cvt_pk_bf16_f32 v148, v128, v129
    v_cvt_pk_bf16_f32 v149, v130, v131
    v_exp_f32 v132, v132
    v_exp_f32 v133, v133
    v_exp_f32 v134, v134
    v_exp_f32 v135, v135
    v_mfma_f32_32x32x16_bf16 v[88:103], v[176:179], v[144:147], v[88:103]
    v_cvt_pk_bf16_f32 v150, v132, v133
    v_cvt_pk_bf16_f32 v151, v134, v135
    v_exp_f32 v104, v104
    v_exp_f32 v105, v105
    v_exp_f32 v106, v106
    v_exp_f32 v107, v107
    v_mfma_f32_32x32x16_bf16 v[120:135], v[200:203], v[32:35], 0
    v_cvt_pk_bf16_f32 v136, v104, v105
    v_cvt_pk_bf16_f32 v137, v106, v107
    v_exp_f32 v108, v108
    v_exp_f32 v109, v109
    v_exp_f32 v110, v110
    v_exp_f32 v111, v111
    v_mfma_f32_32x32x16_bf16 v[120:135], v[204:207], v[36:39], v[120:135]
    ds_write_b128 v222, v[72:75] offset:55552
    ds_write_b128 v222, v[76:79] offset:56576
    v_cvt_pk_bf16_f32 v138, v108, v109
    v_cvt_pk_bf16_f32 v139, v110, v111
    v_exp_f32 v112, v112
    v_exp_f32 v113, v113
    v_exp_f32 v114, v114
    v_exp_f32 v115, v115
    v_mfma_f32_32x32x16_bf16 v[88:103], v[180:183], v[148:151], v[88:103]
    ds_write_b128 v222, v[80:83] offset:57600
    ds_write_b128 v222, v[84:87] offset:58624
    s_mov_b64 exec, 1
    ds_add_u32 v216, v217 offset:44
    s_mov_b64 exec, -1
    v_cvt_pk_bf16_f32 v140, v112, v113
    v_cvt_pk_bf16_f32 v141, v114, v115
    v_exp_f32 v116, v116
    v_exp_f32 v117, v117
    v_exp_f32 v118, v118
    v_exp_f32 v119, v119
    v_mfma_f32_32x32x16_bf16 v[88:103], v[192:195], v[136:139], v[88:103]
    v_cvt_pk_bf16_f32 v142, v116, v117
    v_cvt_pk_bf16_f32 v143, v118, v119
    v_exp_f32 v120, v120
    v_exp_f32 v121, v121
    v_exp_f32 v122, v122
    v_exp_f32 v123, v123
    s_nop 0
    v_cvt_pk_bf16_f32 v144, v120, v121
    v_cvt_pk_bf16_f32 v145, v122, v123
    v_exp_f32 v124, v124
    v_exp_f32 v125, v125
    v_exp_f32 v126, v126
    v_exp_f32 v127, v127
    s_nop 0
    v_cvt_pk_bf16_f32 v146, v124, v125
    v_cvt_pk_bf16_f32 v147, v126, v127
    v_exp_f32 v128, v128
    v_exp_f32 v129, v129
    v_exp_f32 v130, v130
    v_exp_f32 v131, v131
    v_mfma_f32_32x32x16_bf16 v[88:103], v[196:199], v[140:143], v[88:103]
    v_cvt_pk_bf16_f32 v148, v128, v129
    v_cvt_pk_bf16_f32 v149, v130, v131
    v_exp_f32 v132, v132
    v_exp_f32 v133, v133
    v_exp_f32 v134, v134
    v_exp_f32 v135, v135
    v_mfma_f32_32x32x16_bf16 v[88:103], v[208:211], v[144:147], v[88:103]
    v_cvt_pk_bf16_f32 v150, v132, v133
    v_cvt_pk_bf16_f32 v151, v134, v135
    s_nop 1
    v_mfma_f32_32x32x16_bf16 v[88:103], v[212:215], v[148:151], v[88:103]
Lpw_14:
    ds_read_b32 v7, v216 offset:44
    s_waitcnt lgkmcnt(0)
    v_readfirstlane_b32 s3, v7
    s_cmp_ge_u32 s3, 4
    s_cbranch_scc1 Lpw_15
    s_branch Lpw_14
Lpw_15:
    ds_read_b128 v[40:43], v223 offset:47360
    ds_read_b128 v[44:47], v223 offset:48384
    ds_read_b128 v[48:51], v223 offset:49408
    ds_read_b128 v[52:55], v223 offset:50432
    ds_read_b128 v[56:59], v223 offset:51456
    ds_read_b128 v[60:63], v223 offset:52480
    ds_read_b128 v[64:67], v223 offset:53504
    ds_read_b128 v[68:71], v223 offset:54528
    ds_read_b128 v[72:75], v223 offset:55552
    ds_read_b128 v[76:79], v223 offset:56576
    ds_read_b128 v[80:83], v223 offset:57600
    ds_read_b128 v[84:87], v223 offset:58624
    s_waitcnt lgkmcnt(8)
    v_pk_add_f32 v[88:89], v[88:89], v[40:41]
    v_pk_add_f32 v[90:91], v[90:91], v[42:43]
    v_pk_add_f32 v[92:93], v[92:93], v[44:45]
    v_pk_add_f32 v[94:95], v[94:95], v[46:47]
    v_pk_add_f32 v[96:97], v[96:97], v[48:49]
    v_pk_add_f32 v[98:99], v[98:99], v[50:51]
    v_pk_add_f32 v[100:101], v[100:101], v[52:53]
    v_pk_add_f32 v[102:103], v[102:103], v[54:55]
    s_waitcnt lgkmcnt(4)
    v_pk_add_f32 v[88:89], v[88:89], v[56:57]
    v_pk_add_f32 v[90:91], v[90:91], v[58:59]
    v_pk_add_f32 v[92:93], v[92:93], v[60:61]
    v_pk_add_f32 v[94:95], v[94:95], v[62:63]
    v_pk_add_f32 v[96:97], v[96:97], v[64:65]
    v_pk_add_f32 v[98:99], v[98:99], v[66:67]
    v_pk_add_f32 v[100:101], v[100:101], v[68:69]
    v_pk_add_f32 v[102:103], v[102:103], v[70:71]
    s_waitcnt lgkmcnt(0)
    v_pk_add_f32 v[88:89], v[88:89], v[72:73]
    v_pk_add_f32 v[90:91], v[90:91], v[74:75]
    v_pk_add_f32 v[92:93], v[92:93], v[76:77]
    v_pk_add_f32 v[94:95], v[94:95], v[78:79]
    v_pk_add_f32 v[96:97], v[96:97], v[80:81]
    v_pk_add_f32 v[98:99], v[98:99], v[82:83]
    v_pk_add_f32 v[100:101], v[100:101], v[84:85]
    v_pk_add_f32 v[102:103], v[102:103], v[86:87]
L_norm:
    v_rcp_f32 v6, v103
    s_mov_b32 s60, 0x2b800000
    s_mov_b32 s61, 0x53800000
    v_cmp_nle_f32 vcc, s60, v103
    v_cmp_nge_f32 s[56:57], s61, v103
    s_or_b64 vcc, vcc, s[56:57]
    s_cbranch_vccnz L_slow
L_norm2:
    v_pk_mul_f32 v[88:89], v[88:89], v[6:7] op_sel_hi:[1,0]
    v_pk_mul_f32 v[90:91], v[90:91], v[6:7] op_sel_hi:[1,0]
    v_pk_mul_f32 v[92:93], v[92:93], v[6:7] op_sel_hi:[1,0]
    v_pk_mul_f32 v[94:95], v[94:95], v[6:7] op_sel_hi:[1,0]
    v_pk_mul_f32 v[96:97], v[96:97], v[6:7] op_sel_hi:[1,0]
    v_pk_mul_f32 v[98:99], v[98:99], v[6:7] op_sel_hi:[1,0]
    v_pk_mul_f32 v[100:101], v[100:101], v[6:7] op_sel_hi:[1,0]
    v_pk_mul_f32 v[102:103], v[102:103], v[6:7] op_sel_hi:[1,0]
    v_cvt_pk_bf16_f32 v40, v88, v89
    v_cvt_pk_bf16_f32 v41, v90, v91
    v_cvt_pk_bf16_f32 v42, v92, v93
    v_cvt_pk_bf16_f32 v43, v94, v95
    v_cvt_pk_bf16_f32 v44, v96, v97
    v_cvt_pk_bf16_f32 v45, v98, v99
    v_cvt_pk_bf16_f32 v46, v100, v101
    v_cvt_pk_bf16_f32 v47, v102, v103
    v_and_or_b32 v43, v43, s53, v233
    v_and_or_b32 v47, v47, s53, v233
    buffer_store_dwordx4 v[40:43], v232, s[4:7], s52 offen sc1
    buffer_store_dwordx4 v[44:47], v232, s[4:7], s52 offen offset:1024 sc1
    s_endpgm
Lqr_8:
    s_add_u32 s3, s3, 1
    s_cmp_gt_u32 s3, 50000
    s_cbranch_scc1 Lqr_8_b
    buffer_load_dwordx4 v[8:11], v2, s[4:7], s56 offen sc1
    buffer_load_dwordx4 v[12:15], v2, s[4:7], s56 offen offset:1024 sc1
    s_waitcnt vmcnt(0)
    s_branch Lqv_7
Lqr_12:
    s_add_u32 s3, s3, 1
    s_cmp_gt_u32 s3, 50000
    s_cbranch_scc1 Lqr_12_b
    buffer_load_dwordx4 v[16:19], v2, s[4:7], s57 offen sc1
    buffer_load_dwordx4 v[20:23], v2, s[4:7], s57 offen offset:1024 sc1
    buffer_load_dwordx4 v[24:27], v2, s[4:7], s58 offen sc1
    buffer_load_dwordx4 v[28:31], v2, s[4:7], s58 offen offset:1024 sc1
    buffer_load_dwordx4 v[32:35], v2, s[4:7], s59 offen sc1
    buffer_load_dwordx4 v[36:39], v2, s[4:7], s59 offen offset:1024 sc1
    s_waitcnt vmcnt(0)
    s_branch Lqv_11
L_slow:
    s_cmp_eq_u32 s51, 99
    s_cbranch_scc1 L_norm2
    s_mov_b32 s50, 2097152
    v_mov_b32 v40, 0xff800000
Lsl_16:
    buffer_load_dwordx4 v[152:155], v2, s[4:7], s50 offen sc1
    buffer_load_dwordx4 v[156:159], v2, s[4:7], s50 offen offset:1024 sc1
    s_waitcnt vmcnt(0)
    v_mfma_f32_32x32x16_bf16 v[104:119], v[152:155], v[32:35], 0
    v_mfma_f32_32x32x16_bf16 v[104:119], v[156:159], v[36:39], v[104:119]
    s_nop 15
    v_max3_f32 v40, v104, v105, v40
    v_max3_f32 v40, v106, v107, v40
    v_max3_f32 v40, v108, v109, v40
    v_max3_f32 v40, v110, v111, v40
    v_max3_f32 v40, v112, v113, v40
    v_max3_f32 v40, v114, v115, v40
    v_max3_f32 v40, v116, v117, v40
    v_max3_f32 v40, v118, v119, v40
    s_add_u32 s50, s50, 28672
    s_cmp_lt_u32 s50, 3932160
    s_cbranch_scc1 Lsl_16
    v_mov_b32 v41, v40
    s_nop 1
    v_permlane32_swap_b32 v40, v41
    s_nop 1
    v_max_f32 v40, v40, v41
    s_mov_b32 s50, 2097152
    v_mov_b32 v88, 0
    v_mov_b32 v89, 0
    v_mov_b32 v90, 0
    v_mov_b32 v91, 0
    v_mov_b32 v92, 0
    v_mov_b32 v93, 0
    v_mov_b32 v94, 0
    v_mov_b32 v95, 0
    v_mov_b32 v96, 0
    v_mov_b32 v97, 0
    v_mov_b32 v98, 0
    v_mov_b32 v99, 0
    v_mov_b32 v100, 0
    v_mov_b32 v101, 0
    v_mov_b32 v102, 0
    v_mov_b32 v103, 0
Lsl_17:
    buffer_load_dwordx4 v[152:155], v2, s[4:7], s50 offen sc1
    buffer_load_dwordx4 v[156:159], v2, s[4:7], s50 offen offset:1024 sc1
    s_mov_b64 exec, s[54:55]
    buffer_load_dwordx4 v[160:163], v3, s[4:7], s50 offen sc1
    buffer_load_dwordx4 v[164:167], v4, s[4:7], s50 offen sc1
    s_mov_b64 exec, -1
    s_waitcnt vmcnt(0)
    v_mfma_f32_32x32x16_bf16 v[104:119], v[152:155], v[32:35], 0
    v_mfma_f32_32x32x16_bf16 v[104:119], v[156:159], v[36:39], v[104:119]
    s_nop 15
    v_sub_f32 v104, v104, v40
    v_sub_f32 v105, v105, v40
    v_sub_f32 v106, v106, v40
    v_sub_f32 v107, v107, v40
    v_sub_f32 v108, v108, v40
    v_sub_f32 v109, v109, v40
    v_sub_f32 v110, v110, v40
    v_sub_f32 v111, v111, v40
    v_sub_f32 v112, v112, v40
    v_sub_f32 v113, v113, v40
    v_sub_f32 v114, v114, v40
    v_sub_f32 v115, v115, v40
    v_sub_f32 v116, v116, v40
    v_sub_f32 v117, v117, v40
    v_sub_f32 v118, v118, v40
    v_sub_f32 v119, v119, v40
    v_exp_f32 v104, v104
    v_exp_f32 v105, v105
    v_exp_f32 v106, v106
    v_exp_f32 v107, v107
    v_exp_f32 v108, v108
    v_exp_f32 v109, v109
    v_exp_f32 v110, v110
    v_exp_f32 v111, v111
    v_exp_f32 v112, v112
    v_exp_f32 v113, v113
    v_exp_f32 v114, v114
    v_exp_f32 v115, v115
    v_exp_f32 v116, v116
    v_exp_f32 v117, v117
    v_exp_f32 v118, v118
    v_exp_f32 v119, v119
    s_nop 0
    v_cvt_pk_bf16_f32 v136, v104, v105
    v_cvt_pk_bf16_f32 v137, v106, v107
    v_cvt_pk_bf16_f32 v138, v108, v109
    v_cvt_pk_bf16_f32 v139, v110, v111
    v_cvt_pk_bf16_f32 v140, v112, v113
    v_cvt_pk_bf16_f32 v141, v114, v115
    v_cvt_pk_bf16_f32 v142, v116, v117
    v_cvt_pk_bf16_f32 v143, v118, v119
    s_nop 1
    v_mfma_f32_32x32x16_bf16 v[88:103], v[160:163], v[136:139], v[88:103]
    v_mfma_f32_32x32x16_bf16 v[88:103], v[164:167], v[140:143], v[88:103]
    s_add_u32 s50, s50, 28672
    s_cmp_lt_u32 s50, 3932160
    s_cbranch_scc1 Lsl_17
    s_mov_b32 s51, 99
    s_nop 15
    s_branch L_norm
L_B:
    s_mov_b32 s8, s64
    s_mov_b32 s9, s65
    s_mov_b32 s10, 1835008
    s_mov_b32 s11, 0x00020000
    s_mov_b32 s12, s66
    s_mov_b32 s13, s67
    s_mov_b32 s14, 1204224
    s_mov_b32 s15, 0x00020000
    s_mov_b32 s28, s86
    s_mov_b32 s29, s87
    s_mov_b32 s30, 256
    s_mov_b32 s31, 0x00020000
    s_mov_b32 s4, s88
    s_mov_b32 s5, s89
    s_mov_b32 s6, 16777216
    s_mov_b32 s7, 0x00020000
    s_mov_b32 s16, s68
    s_mov_b32 s17, s69
    s_mov_b32 s18, 401408
    s_mov_b32 s19, 0x00020000
    s_mov_b32 s24, s84
    s_mov_b32 s25, s85
    s_mov_b32 s26, 3670016
    s_mov_b32 s27, 0x00020000
    s_lshl_b32 s76, s92, 7
    s_add_u32 s76, s76, s93
    s_mul_i32 s83, s92, 172032
    s_add_u32 s83, s83, s94
    s_add_u32 s92, s92, 1
    s_cmp_eq_u32 s92, 7
    s_cselect_b32 s92, 0, s92
    s_lshl_b32 s77, s92, 7
    s_add_u32 s77, s77, s93
    s_mul_i32 s84, s92, 172032
    s_add_u32 s84, s84, s94
    s_add_u32 s92, s92, 1
    s_cmp_eq_u32 s92, 7
    s_cselect_b32 s92, 0, s92
    s_lshl_b32 s78, s92, 7
    s_add_u32 s78, s78, s93
    s_mul_i32 s85, s92, 172032
    s_add_u32 s85, s85, s94
    s_add_u32 s92, s92, 1
    s_cmp_eq_u32 s92, 7
    s_cselect_b32 s92, 0, s92
    s_lshl_b32 s79, s92, 7
    s_add_u32 s79, s79, s93
    s_mul_i32 s86, s92, 172032
    s_add_u32 s86, s86, s94
    s_add_u32 s92, s92, 1
    s_cmp_eq_u32 s92, 7
    s_cselect_b32 s92, 0, s92
    s_lshl_b32 s80, s92, 7
    s_add_u32 s80, s80, s93
    s_mul_i32 s87, s92, 172032
    s_add_u32 s87, s87, s94
    s_add_u32 s92, s92, 1
    s_cmp_eq_u32 s92, 7
    s_cselect_b32 s92, 0, s92
    s_lshl_b32 s81, s92, 7
    s_add_u32 s81, s81, s93
    s_mul_i32 s88, s92, 172032
    s_add_u32 s88, s88, s94
    s_add_u32 s92, s92, 1
    s_cmp_eq_u32 s92, 7
    s_cselect_b32 s92, 0, s92
    s_lshl_b32 s82, s92, 7
    s_add_u32 s82, s82, s93
    s_mul_i32 s89, s92, 172032
    s_add_u32 s89, s89, s94
    s_add_u32 s92, s92, 1
    s_cmp_eq_u32 s92, 7
    s_cselect_b32 s92, 0, s92
    s_mul_i32 s45, s42, 8704
    s_add_u32 s45, s45, 12544
    s_mul_i32 s61, s43, 17408
    s_add_u32 s61, s61, 12544
    v_and_b32 v8, 3, v0
    v_bfe_u32 v9, v0, 3, 2
    v_lshl_add_u32 v8, v9, 2, v8
    v_bfe_u32 v9, v0, 2, 1
    v_lshl_add_u32 v8, v9, 4, v8
    v_lshrrev_b32 v9, 5, v0
    v_lshlrev_b32 v10, 3, v9
    v_sub_u32 v8, v8, v10
    v_add_u32 v8, 9, v8
    v_sub_u32 v10, 0, v8
    v_and_b32 v10, 3, v10
    v_add_lshl_u32 v8, v8, v10, 1
    v_mul_u32_u24 v10, 4160, v10
    s_lshl_b32 s55, s44, 10
    s_add_u32 s55, s55, s61
    v_add3_u32 v204, v8, v10, s55
    v_lshlrev_b32 v176, 4, v0
    s_lshl_b32 s55, s44, 11
    s_add_u32 s55, s55, s61
    v_add_u32 v206, s55, v176
    v_add_u32 v176, s45, v176
    v_and_b32 v8, 31, v0
    v_mul_u32_u24 v21, 272, v8
    v_lshl_add_u32 v21, v9, 4, v21
    v_add_u32 v21, s45, v21
    v_lshlrev_b32 v203, 7, v8
    v_lshlrev_b32 v8, 4, v8
    v_mul_u32_u24 v10, 1568, v9
    s_mul_i32 s56, s43, 6272
    s_lshl_b32 s55, s44, 8
    s_sub_u32 s55, s56, s55
    s_add_u32 s55, s55, 480
    v_add3_u32 v205, v8, v10, s55
    v_and_b32 v8, 3, v0
    v_mul_u32_u24 v8, 1568, v8
    v_lshrrev_b32 v9, 2, v0
    v_lshl_add_u32 v8, v9, 4, v8
    v_add_u32 v202, s56, v8
    v_lshrrev_b32 v8, 4, v0
    v_mul_u32_u24 v8, 4160, v8
    v_and_b32 v9, 15, v0
    v_lshl_add_u32 v8, v9, 2, v8
    v_add_u32 v201, s61, v8
    s_lshr_b32 s58, s47, 1
    s_add_u32 s58, s58, s43
    s_lshl_b32 s55, s37, 12
    s_add_u32 s55, s55, 12697600
    v_add_u32 v203, s55, v203
    s_mul_i32 s57, s58, 4224
    s_lshl_b32 s55, s44, 11
    s_add_u32 s57, s57, s55
    s_add_u32 s57, s57, 8388728
    v_mov_b32 v27, 0x3f80
    v_mov_b32 v252, 0
    v_mov_b32 v253, 0
    v_mov_b32 v254, 0
    v_mov_b32 v255, 0
    s_bitcmp1_b32 s44, 0
    s_mov_b32 s52, 0xffff
    s_cselect_b32 s52, 0xffff8000, s52
    s_waitcnt lgkmcnt(0)
    s_lshl_b32 s3, s43, 4
    s_lshr_b32 s48, s48, s3
    s_lshl_b32 s48, s48, 16
    s_lshr_b32 s49, s49, s3
    s_lshl_b32 s49, s49, 16
    v_mov_b32 v22, 0x3fb8aa3b
    v_mul_f32 v20, s48, v22
    v_exp_f32 v20, v20
    s_lshl_b32 s50, s37, 2
    v_cvt_pk_bf16_f32 v20, v20, v20
    v_and_b32 v20, 0xffff0000, v20
    s_add_u32 s50, s50, s42
    s_mul_i32 s50, s50, 67584
    s_lshl_b32 s55, s38, 7
    s_add_u32 s50, s50, s55
    s_add_u32 s50, s50, 8388736
    s_add_u32 s51, s50, 33792
    s_lshl_b32 s59, s47, 5
    s_add_u32 s59, s59, 12697600
    v_lshrrev_b32 v180, 4, v0
    v_and_b32 v178, 15, v0
    v_lshlrev_b32 v177, 9, v180
    v_lshl_add_u32 v177, v178, 3, v177
    v_add_u32 v177, s45, v177
    v_mul_u32_u24 v178, 144, v178
    v_lshl_add_u32 v178, v180, 5, v178
    v_add_u32 v178, s45, v178
    v_lshrrev_b32 v180, 3, v0
    v_mul_u32_u24 v179, 144, v180
    v_mul_u32_u24 v180, 4224, v180
    v_and_b32 v8, 7, v0
    v_lshl_add_u32 v179, v8, 4, v179
    v_add_u32 v179, s45, v179
    v_lshl_add_u32 v180, v8, 4, v180
    s_waitcnt vmcnt(2)
    v_lshlrev_b32 v16, 16, v12
    v_lshlrev_b32 v17, 16, v13
    v_lshlrev_b32 v18, 16, v14
    v_lshlrev_b32 v19, 16, v15
    v_mul_f32 v22, 0x3fb8aa3b, v16
    v_exp_f32 v22, v22
    v_mul_f32 v23, v17, v20
    v_cvt_pk_bf16_f32 v22, v22, v22
    v_and_b32 v22, 0xffff0000, v22
    v_mul_f32 v22, v22, v20
    v_mul_f32 v22, 0xbfb8aa3b, v22
    v_mul_f32 v17, 0.15915494, v23
    v_fma_f32 v16, 0.15915494, v23, -v17
    v_fmac_f32 v16, 0x31dc9c88, v23
    v_add_f32 v24, v20, v20
    v_mul_f32 v40, v18, v24
    v_mul_f32 v41, v19, v24
    v_mul_f32 v24, 0x3f800000, v22
    v_mul_f32 v25, 0x3f800000, v17
    v_exp_f32 v24, v24
    v_fract_f32 v25, v25
    v_fmac_f32 v25, 0x3f800000, v16
    v_cos_f32 v28, v25
    v_sin_f32 v29, v25
    v_mul_f32 v28, v28, v24
    v_mul_f32 v29, v29, v24
    v_mul_f32 v24, 0x41000000, v22
    v_mul_f32 v25, 0x41000000, v17
    v_exp_f32 v24, v24
    v_fract_f32 v25, v25
    v_fmac_f32 v25, 0x41000000, v16
    v_cos_f32 v34, v25
    v_sin_f32 v35, v25
    v_mul_f32 v34, v34, v24
    v_mul_f32 v35, v35, v24
    v_mul_f32 v24, 0x43800000, v22
    v_mul_f32 v25, 0x43800000, v17
    v_exp_f32 v24, v24
    v_fract_f32 v25, v25
    v_fmac_f32 v25, 0x43800000, v16
    v_cos_f32 v36, v25
    v_sin_f32 v37, v25
    v_mul_f32 v36, v36, v24
    v_mul_f32 v37, v37, v24
    v_pk_mul_f32 v[30:31], v[28:29], v[28:29] op_sel:[0,0] op_sel_hi:[1,0]
    v_pk_fma_f32 v[30:31], v[28:29], v[28:29], v[30:31] op_sel:[1,1,0] op_sel_hi:[0,1,1] neg_lo:[0,1,0]
    v_pk_mul_f32 v[32:33], v[30:31], v[30:31] op_sel:[0,0] op_sel_hi:[1,0]
    v_pk_fma_f32 v[32:33], v[30:31], v[30:31], v[32:33] op_sel:[1,1,0] op_sel_hi:[0,1,1] neg_lo:[0,1,0]
    v_pk_mul_f32 v[38:39], v[34:35], v[34:35] op_sel:[0,0] op_sel_hi:[1,0]
    v_pk_fma_f32 v[38:39], v[34:35], v[34:35], v[38:39] op_sel:[1,1,0] op_sel_hi:[0,1,1] neg_lo:[0,1,0]
    v_pk_mul_f32 v[44:45], v[40:41], v[36:37] op_sel:[0,0] op_sel_hi:[1,0]
    v_pk_fma_f32 v[44:45], v[40:41], v[36:37], v[44:45] op_sel:[1,1,0] op_sel_hi:[0,1,1] neg_lo:[0,1,0]
    s_waitcnt vmcnt(0)
    ds_write_b128 v176, v[168:171] offset:0
    ds_write_b128 v176, v[172:175] offset:1024
    ds_read_b64_tr_b16 v[168:169], v177 offset:0
    ds_read_b64_tr_b16 v[170:171], v177 offset:128
    ds_read_b64_tr_b16 v[172:173], v177 offset:256
    ds_read_b64_tr_b16 v[174:175], v177 offset:384
    s_waitcnt lgkmcnt(0)
    ds_write_b128 v178, v[168:171] offset:0
    ds_write_b128 v178, v[172:175] offset:16
    ds_read_b128 v[168:171], v179 offset:0
    ds_read_b128 v[172:175], v179 offset:1152
    v_cvt_pk_bf16_f32 v48, v40, -v41
    v_pk_mul_f32 v[42:43], v[40:41], v[28:29] op_sel:[0,0] op_sel_hi:[1,0]
    v_pk_fma_f32 v[42:43], v[40:41], v[28:29], v[42:43] op_sel:[1,1,0] op_sel_hi:[0,1,1] neg_lo:[0,1,0]
    v_cvt_pk_bf16_f32 v49, v42, -v43
    v_pk_mul_f32 v[40:41], v[42:43], v[28:29] op_sel:[0,0] op_sel_hi:[1,0]
    v_pk_fma_f32 v[40:41], v[42:43], v[28:29], v[40:41] op_sel:[1,1,0] op_sel_hi:[0,1,1] neg_lo:[0,1,0]
    v_cvt_pk_bf16_f32 v50, v40, -v41
    v_pk_mul_f32 v[42:43], v[40:41], v[28:29] op_sel:[0,0] op_sel_hi:[1,0]
    v_pk_fma_f32 v[42:43], v[40:41], v[28:29], v[42:43] op_sel:[1,1,0] op_sel_hi:[0,1,1] neg_lo:[0,1,0]
    v_cvt_pk_bf16_f32 v51, v42, -v43
    v_pk_mul_f32 v[40:41], v[42:43], v[28:29] op_sel:[0,0] op_sel_hi:[1,0]
    v_pk_fma_f32 v[40:41], v[42:43], v[28:29], v[40:41] op_sel:[1,1,0] op_sel_hi:[0,1,1] neg_lo:[0,1,0]
    v_cvt_pk_bf16_f32 v52, v40, -v41
    v_pk_mul_f32 v[42:43], v[40:41], v[28:29] op_sel:[0,0] op_sel_hi:[1,0]
    v_pk_fma_f32 v[42:43], v[40:41], v[28:29], v[42:43] op_sel:[1,1,0] op_sel_hi:[0,1,1] neg_lo:[0,1,0]
    v_cvt_pk_bf16_f32 v53, v42, -v43
    v_pk_mul_f32 v[40:41], v[42:43], v[28:29] op_sel:[0,0] op_sel_hi:[1,0]
    v_pk_fma_f32 v[40:41], v[42:43], v[28:29], v[40:41] op_sel:[1,1,0] op_sel_hi:[0,1,1] neg_lo:[0,1,0]
    v_cvt_pk_bf16_f32 v54, v40, -v41
    v_pk_mul_f32 v[42:43], v[40:41], v[28:29] op_sel:[0,0] op_sel_hi:[1,0]
    v_pk_fma_f32 v[42:43], v[40:41], v[28:29], v[42:43] op_sel:[1,1,0] op_sel_hi:[0,1,1] neg_lo:[0,1,0]
    v_cvt_pk_bf16_f32 v55, v42, -v43
    v_cvt_pk_bf16_f32 v56, v44, -v45
    v_pk_mul_f32 v[40:41], v[44:45], v[30:31] op_sel:[0,0] op_sel_hi:[1,0]
    v_pk_fma_f32 v[40:41], v[44:45], v[30:31], v[40:41] op_sel:[1,1,0] op_sel_hi:[0,1,1] neg_lo:[0,1,0]
    v_cvt_pk_bf16_f32 v57, v40, -v41
    v_pk_mul_f32 v[42:43], v[40:41], v[30:31] op_sel:[0,0] op_sel_hi:[1,0]
    v_pk_fma_f32 v[42:43], v[40:41], v[30:31], v[42:43] op_sel:[1,1,0] op_sel_hi:[0,1,1] neg_lo:[0,1,0]
    v_cvt_pk_bf16_f32 v58, v42, -v43
    v_pk_mul_f32 v[40:41], v[42:43], v[30:31] op_sel:[0,0] op_sel_hi:[1,0]
    v_pk_fma_f32 v[40:41], v[42:43], v[30:31], v[40:41] op_sel:[1,1,0] op_sel_hi:[0,1,1] neg_lo:[0,1,0]
    v_cvt_pk_bf16_f32 v59, v40, -v41
    v_pk_mul_f32 v[42:43], v[40:41], v[30:31] op_sel:[0,0] op_sel_hi:[1,0]
    v_pk_fma_f32 v[42:43], v[40:41], v[30:31], v[42:43] op_sel:[1,1,0] op_sel_hi:[0,1,1] neg_lo:[0,1,0]
    v_cvt_pk_bf16_f32 v60, v42, -v43
    v_pk_mul_f32 v[46:47], v[44:45], v[36:37] op_sel:[0,0] op_sel_hi:[1,0]
    v_pk_fma_f32 v[46:47], v[44:45], v[36:37], v[46:47] op_sel:[1,1,0] op_sel_hi:[0,1,1] neg_lo:[0,1,0]
    v_cvt_pk_bf16_f32 v61, v46, -v47
    v_pk_mul_f32 v[40:41], v[46:47], v[32:33] op_sel:[0,0] op_sel_hi:[1,0]
    v_pk_fma_f32 v[40:41], v[46:47], v[32:33], v[40:41] op_sel:[1,1,0] op_sel_hi:[0,1,1] neg_lo:[0,1,0]
    v_cvt_pk_bf16_f32 v62, v40, -v41
    v_pk_mul_f32 v[42:43], v[46:47], v[34:35] op_sel:[0,0] op_sel_hi:[1,0]
    v_pk_fma_f32 v[42:43], v[46:47], v[34:35], v[42:43] op_sel:[1,1,0] op_sel_hi:[0,1,1] neg_lo:[0,1,0]
    v_cvt_pk_bf16_f32 v63, v42, -v43
    v_pk_mul_f32 v[44:45], v[46:47], v[36:37] op_sel:[0,0] op_sel_hi:[1,0]
    v_pk_fma_f32 v[44:45], v[46:47], v[36:37], v[44:45] op_sel:[1,1,0] op_sel_hi:[0,1,1] neg_lo:[0,1,0]
    v_cvt_pk_bf16_f32 v64, v44, -v45
    v_pk_mul_f32 v[40:41], v[44:45], v[32:33] op_sel:[0,0] op_sel_hi:[1,0]
    v_pk_fma_f32 v[40:41], v[44:45], v[32:33], v[40:41] op_sel:[1,1,0] op_sel_hi:[0,1,1] neg_lo:[0,1,0]
    v_cvt_pk_bf16_f32 v65, v40, -v41
    v_pk_mul_f32 v[42:43], v[44:45], v[34:35] op_sel:[0,0] op_sel_hi:[1,0]
    v_pk_fma_f32 v[42:43], v[44:45], v[34:35], v[42:43] op_sel:[1,1,0] op_sel_hi:[0,1,1] neg_lo:[0,1,0]
    v_cvt_pk_bf16_f32 v66, v42, -v43
    v_pk_mul_f32 v[46:47], v[44:45], v[36:37] op_sel:[0,0] op_sel_hi:[1,0]
    v_pk_fma_f32 v[46:47], v[44:45], v[36:37], v[46:47] op_sel:[1,1,0] op_sel_hi:[0,1,1] neg_lo:[0,1,0]
    v_cvt_pk_bf16_f32 v67, v46, -v47
    v_pk_mul_f32 v[40:41], v[46:47], v[34:35] op_sel:[0,0] op_sel_hi:[1,0]
    v_pk_fma_f32 v[40:41], v[46:47], v[34:35], v[40:41] op_sel:[1,1,0] op_sel_hi:[0,1,1] neg_lo:[0,1,0]
    v_cvt_pk_bf16_f32 v68, v40, -v41
    v_pk_mul_f32 v[44:45], v[46:47], v[36:37] op_sel:[0,0] op_sel_hi:[1,0]
    v_pk_fma_f32 v[44:45], v[46:47], v[36:37], v[44:45] op_sel:[1,1,0] op_sel_hi:[0,1,1] neg_lo:[0,1,0]
    v_cvt_pk_bf16_f32 v69, v44, -v45
    v_pk_mul_f32 v[40:41], v[44:45], v[34:35] op_sel:[0,0] op_sel_hi:[1,0]
    v_pk_fma_f32 v[40:41], v[44:45], v[34:35], v[40:41] op_sel:[1,1,0] op_sel_hi:[0,1,1] neg_lo:[0,1,0]
    v_cvt_pk_bf16_f32 v70, v40, -v41
    v_pk_mul_f32 v[46:47], v[44:45], v[36:37] op_sel:[0,0] op_sel_hi:[1,0]
    v_pk_fma_f32 v[46:47], v[44:45], v[36:37], v[46:47] op_sel:[1,1,0] op_sel_hi:[0,1,1] neg_lo:[0,1,0]
    v_cvt_pk_bf16_f32 v71, v46, -v47
    v_pk_mul_f32 v[40:41], v[46:47], v[34:35] op_sel:[0,0] op_sel_hi:[1,0]
    v_pk_fma_f32 v[40:41], v[46:47], v[34:35], v[40:41] op_sel:[1,1,0] op_sel_hi:[0,1,1] neg_lo:[0,1,0]
    v_cvt_pk_bf16_f32 v72, v40, -v41
    v_pk_mul_f32 v[44:45], v[46:47], v[36:37] op_sel:[0,0] op_sel_hi:[1,0]
    v_pk_fma_f32 v[44:45], v[46:47], v[36:37], v[44:45] op_sel:[1,1,0] op_sel_hi:[0,1,1] neg_lo:[0,1,0]
    v_cvt_pk_bf16_f32 v73, v44, -v45
    v_pk_mul_f32 v[40:41], v[44:45], v[34:35] op_sel:[0,0] op_sel_hi:[1,0]
    v_pk_fma_f32 v[40:41], v[44:45], v[34:35], v[40:41] op_sel:[1,1,0] op_sel_hi:[0,1,1] neg_lo:[0,1,0]
    v_cvt_pk_bf16_f32 v74, v40, -v41
    v_cvt_pk_bf16_f32 v75, v34, v35
    v_cvt_pk_bf16_f32 v76, v38, v39
    v_pk_mul_f32 v[40:41], v[34:35], v[38:39] op_sel:[0,0] op_sel_hi:[1,0]
    v_pk_fma_f32 v[40:41], v[34:35], v[38:39], v[40:41] op_sel:[1,1,0] op_sel_hi:[0,1,1] neg_lo:[0,1,0]
    v_cvt_pk_bf16_f32 v77, v40, v41
    v_pk_mul_f32 v[44:45], v[38:39], v[38:39] op_sel:[0,0] op_sel_hi:[1,0]
    v_pk_fma_f32 v[44:45], v[38:39], v[38:39], v[44:45] op_sel:[1,1,0] op_sel_hi:[0,1,1] neg_lo:[0,1,0]
    v_cvt_pk_bf16_f32 v78, v44, v45
    v_pk_mul_f32 v[42:43], v[40:41], v[38:39] op_sel:[0,0] op_sel_hi:[1,0]
    v_pk_fma_f32 v[42:43], v[40:41], v[38:39], v[42:43] op_sel:[1,1,0] op_sel_hi:[0,1,1] neg_lo:[0,1,0]
    v_cvt_pk_bf16_f32 v79, v42, v43
    v_pk_mul_f32 v[46:47], v[44:45], v[38:39] op_sel:[0,0] op_sel_hi:[1,0]
    v_pk_fma_f32 v[46:47], v[44:45], v[38:39], v[46:47] op_sel:[1,1,0] op_sel_hi:[0,1,1] neg_lo:[0,1,0]
    v_cvt_pk_bf16_f32 v80, v46, v47
    v_pk_mul_f32 v[40:41], v[42:43], v[38:39] op_sel:[0,0] op_sel_hi:[1,0]
    v_pk_fma_f32 v[40:41], v[42:43], v[38:39], v[40:41] op_sel:[1,1,0] op_sel_hi:[0,1,1] neg_lo:[0,1,0]
    v_cvt_pk_bf16_f32 v81, v40, v41
    s_barrier
    s_add_u32 m0, s90, 96512
    s_nop 0
    buffer_load_dwordx4 v2, s[8:11], s78 offen lds
    v_mul_f32 v44, v46, v38
    v_mul_f32 v45, v47, v38
    v_fma_f32 v44, -v47, v39, v44
    v_fmac_f32 v45, v46, v39
    v_cvt_pk_bf16_f32 v82, v44, v45
    v_mul_f32 v42, v40, v38
    v_mul_f32 v43, v41, v38
    v_fma_f32 v42, -v41, v39, v42
    v_fmac_f32 v43, v40, v39
    v_cvt_pk_bf16_f32 v83, v42, v43
    s_add_u32 m0, s90, 97536
    s_nop 0
    buffer_load_dwordx4 v3, s[8:11], s78 offen lds
    v_mul_f32 v46, v44, v38
    v_mul_f32 v47, v45, v38
    v_fma_f32 v46, -v45, v39, v46
    v_fmac_f32 v47, v44, v39
    v_cvt_pk_bf16_f32 v84, v46, v47
    v_mul_f32 v40, v42, v38
    v_mul_f32 v41, v43, v38
    v_fma_f32 v40, -v43, v39, v40
    v_fmac_f32 v41, v42, v39
    v_cvt_pk_bf16_f32 v85, v40, v41
    s_add_u32 m0, s90, 104704
    s_add_u32 s91, s85, 896
    buffer_load_dwordx4 v4, s[12:15], s91 offen lds
    v_mul_f32 v44, v46, v38
    v_mul_f32 v45, v47, v38
    v_fma_f32 v44, -v47, v39, v44
    v_fmac_f32 v45, v46, v39
    v_cvt_pk_bf16_f32 v86, v44, v45
    v_mul_f32 v42, v40, v38
    v_mul_f32 v43, v41, v38
    v_fma_f32 v42, -v41, v39, v42
    v_fmac_f32 v43, v40, v39
    v_cvt_pk_bf16_f32 v87, v42, v43
    s_add_u32 m0, s90, 105728
    s_nop 0
    buffer_load_dwordx4 v5, s[12:15], s91 offen lds
    v_mul_f32 v46, v44, v38
    v_mul_f32 v47, v45, v38
    v_fma_f32 v46, -v45, v39, v46
    v_fmac_f32 v47, v44, v39
    v_cvt_pk_bf16_f32 v88, v46, v47
    v_mul_f32 v40, v42, v38
    v_mul_f32 v41, v43, v38
    v_fma_f32 v40, -v43, v39, v40
    v_fmac_f32 v41, v42, v39
    v_cvt_pk_bf16_f32 v89, v40, v41
    v_mul_f32 v44, v46, v38
    s_add_u32 m0, s90, 112896
    s_add_u32 s91, s85, 1792
    buffer_load_dwordx4 v4, s[12:15], s91 offen lds
    v_mul_f32 v45, v47, v38
    v_fma_f32 v44, -v47, v39, v44
    v_fmac_f32 v45, v46, v39
    v_cvt_pk_bf16_f32 v90, v44, v45
    v_mul_f32 v42, v40, v38
    v_mul_f32 v43, v41, v38
    v_fma_f32 v42, -v41, v39, v42
    v_fmac_f32 v43, v40, v39
    v_cvt_pk_bf16_f32 v91, v42, v43
    v_mul_f32 v46, v44, v38
    s_add_u32 m0, s90, 113920
    s_nop 0
    buffer_load_dwordx4 v5, s[12:15], s91 offen lds
    v_mul_f32 v47, v45, v38
    v_fma_f32 v46, -v45, v39, v46
    v_fmac_f32 v47, v44, v39
    v_cvt_pk_bf16_f32 v92, v46, v47
    v_mul_f32 v40, v42, v38
    v_mul_f32 v41, v43, v38
    v_fma_f32 v40, -v43, v39, v40
    v_fmac_f32 v41, v42, v39
    v_cvt_pk_bf16_f32 v93, v40, v41
    v_mul_f32 v44, v46, v38
    s_add_u32 m0, s90, 121088
    s_nop 0
    buffer_load_dwordx4 v2, s[8:11], s79 offen lds
    v_mul_f32 v45, v47, v38
    v_fma_f32 v44, -v47, v39, v44
    v_fmac_f32 v45, v46, v39
    v_cvt_pk_bf16_f32 v94, v44, v45
    v_mul_f32 v42, v40, v38
    v_mul_f32 v43, v41, v38
    v_fma_f32 v42, -v41, v39, v42
    v_fmac_f32 v43, v40, v39
    v_cvt_pk_bf16_f32 v95, v42, v43
    v_mul_f32 v46, v44, v38
    v_mul_f32 v47, v45, v38
    s_add_u32 m0, s90, 122112
    s_nop 0
    buffer_load_dwordx4 v3, s[8:11], s79 offen lds
    v_fma_f32 v46, -v45, v39, v46
    v_fmac_f32 v47, v44, v39
    v_cvt_pk_bf16_f32 v96, v46, v47
    v_mul_f32 v40, v42, v38
    v_mul_f32 v41, v43, v38
    v_fma_f32 v40, -v43, v39, v40
    v_fmac_f32 v41, v42, v39
    v_cvt_pk_bf16_f32 v97, v40, v41
    v_mul_f32 v44, v46, v38
    v_mul_f32 v45, v47, v38
    s_waitcnt lgkmcnt(0)
    buffer_store_dwordx4 v[168:171], v180, s[4:7], s50 offen sc1
    buffer_store_dwordx4 v[172:175], v180, s[4:7], s51 offen sc1
    buffer_load_dword v200, off, s[28:31], 0 sc1
    s_cmp_lg_u32 s38, 0
    s_cbranch_scc1 Lz_18
    s_sub_u32 s50, s50, 128
    s_sub_u32 s51, s51, 128
    buffer_store_dwordx4 v[252:255], v180, s[4:7], s50 offen sc1
    buffer_store_dwordx4 v[252:255], v180, s[4:7], s51 offen sc1
Lz_18:
    s_barrier
    s_add_u32 m0, s90, 129280
    s_add_u32 s91, s86, 896
    buffer_load_dwordx4 v4, s[12:15], s91 offen lds
    v_fma_f32 v44, -v47, v39, v44
    v_fmac_f32 v45, v46, v39
    v_cvt_pk_bf16_f32 v98, v44, v45
    v_mul_f32 v42, v40, v38
    v_mul_f32 v43, v41, v38
    v_fma_f32 v42, -v41, v39, v42
    v_fmac_f32 v43, v40, v39
    v_cvt_pk_bf16_f32 v99, v42, v43
    v_mul_f32 v46, v44, v38
    v_mul_f32 v47, v45, v38
    s_add_u32 m0, s90, 130304
    s_nop 0
    buffer_load_dwordx4 v5, s[12:15], s91 offen lds
    v_fma_f32 v46, -v45, v39, v46
    v_fmac_f32 v47, v44, v39
    v_cvt_pk_bf16_f32 v100, v46, v47
    v_mul_f32 v40, v42, v38
    v_mul_f32 v41, v43, v38
    v_fma_f32 v40, -v43, v39, v40
    v_fmac_f32 v41, v42, v39
    v_cvt_pk_bf16_f32 v101, v40, v41
    v_mul_f32 v44, v46, v38
    v_mul_f32 v45, v47, v38
    v_fma_f32 v44, -v47, v39, v44
    s_add_u32 m0, s90, 137472
    s_add_u32 s91, s86, 1792
    buffer_load_dwordx4 v4, s[12:15], s91 offen lds
    v_fmac_f32 v45, v46, v39
    v_cvt_pk_bf16_f32 v102, v44, v45
    v_mul_f32 v42, v40, v38
    v_mul_f32 v43, v41, v38
    v_fma_f32 v42, -v41, v39, v42
    v_fmac_f32 v43, v40, v39
    v_cvt_pk_bf16_f32 v103, v42, v43
    v_mul_f32 v46, v44, v38
    v_mul_f32 v47, v45, v38
    v_fma_f32 v46, -v45, v39, v46
    s_add_u32 m0, s90, 138496
    s_nop 0
    buffer_load_dwordx4 v5, s[12:15], s91 offen lds
    v_fmac_f32 v47, v44, v39
    v_cvt_pk_bf16_f32 v104, v46, v47
    v_mul_f32 v40, v42, v38
    v_mul_f32 v41, v43, v38
    v_fma_f32 v40, -v43, v39, v40
    v_fmac_f32 v41, v42, v39
    v_cvt_pk_bf16_f32 v105, v40, v41
    v_and_b32 v16, 0xffff0000, v12
    v_and_b32 v17, 0xffff0000, v13
    v_and_b32 v18, 0xffff0000, v14
    s_add_u32 m0, s90, 145664
    s_nop 0
    buffer_load_dwordx4 v2, s[8:11], s80 offen lds
    v_and_b32 v19, 0xffff0000, v15
    v_mul_f32 v22, 0x3fb8aa3b, v16
    v_exp_f32 v22, v22
    v_mul_f32 v23, v17, v20
    v_cvt_pk_bf16_f32 v22, v22, v22
    v_and_b32 v22, 0xffff0000, v22
    v_mul_f32 v22, v22, v20
    v_mul_f32 v22, 0xbfb8aa3b, v22
    v_mul_f32 v17, 0.15915494, v23
    v_fma_f32 v16, 0.15915494, v23, -v17
    v_fmac_f32 v16, 0x31dc9c88, v23
    s_add_u32 m0, s90, 146688
    s_nop 0
    buffer_load_dwordx4 v3, s[8:11], s80 offen lds
    v_add_f32 v24, v20, v20
    v_mul_f32 v40, v18, v24
    v_mul_f32 v41, v19, v24
    v_mul_f32 v24, 0x3f800000, v22
    v_mul_f32 v25, 0x3f800000, v17
    v_exp_f32 v24, v24
    v_fract_f32 v25, v25
    v_fmac_f32 v25, 0x3f800000, v16
    v_cos_f32 v28, v25
    v_sin_f32 v29, v25
    s_add_u32 m0, s90, 153856
    s_add_u32 s91, s87, 896
    buffer_load_dwordx4 v4, s[12:15], s91 offen lds
    v_mul_f32 v28, v28, v24
    v_mul_f32 v29, v29, v24
    v_mul_f32 v24, 0x41000000, v22
    v_mul_f32 v25, 0x41000000, v17
    v_exp_f32 v24, v24
    v_fract_f32 v25, v25
    v_fmac_f32 v25, 0x41000000, v16
    v_cos_f32 v34, v25
    v_sin_f32 v35, v25
    v_mul_f32 v34, v34, v24
    s_add_u32 m0, s90, 154880
    s_nop 0
    buffer_load_dwordx4 v5, s[12:15], s91 offen lds
    v_mul_f32 v35, v35, v24
    v_mul_f32 v24, 0x43800000, v22
    v_mul_f32 v25, 0x43800000, v17
    v_exp_f32 v24, v24
    v_fract_f32 v25, v25
    v_fmac_f32 v25, 0x43800000, v16
    v_cos_f32 v36, v25
    v_sin_f32 v37, v25
    v_mul_f32 v36, v36, v24
    v_mul_f32 v37, v37, v24
    v_mul_f32 v30, v28, v28
    s_waitcnt vmcnt(13)
    s_barrier
    s_add_u32 m0, s90, 47360
    s_add_u32 s91, s87, 1792
    buffer_load_dwordx4 v4, s[12:15], s91 offen lds
    v_mul_f32 v31, v29, v28
    v_fma_f32 v30, -v29, v29, v30
    v_fmac_f32 v31, v28, v29
    v_mul_f32 v32, v30, v30
    v_mul_f32 v33, v31, v30
    v_fma_f32 v32, -v31, v31, v32
    v_fmac_f32 v33, v30, v31
    v_mul_f32 v38, v34, v34
    v_mul_f32 v39, v35, v34
    v_fma_f32 v38, -v35, v35, v38
    s_add_u32 m0, s90, 48384
    s_nop 0
    buffer_load_dwordx4 v5, s[12:15], s91 offen lds
    v_fmac_f32 v39, v34, v35
    v_mul_f32 v44, v40, v36
    v_mul_f32 v45, v41, v36
    v_fma_f32 v44, -v41, v37, v44
    v_fmac_f32 v45, v40, v37
    v_cvt_pk_bf16_f32 v108, v40, -v41
    v_mul_f32 v42, v40, v28
    v_mul_f32 v43, v41, v28
    v_fma_f32 v42, -v41, v29, v42
    v_fmac_f32 v43, v40, v29
    s_add_u32 m0, s90, 55552
    s_nop 0
    buffer_load_dwordx4 v2, s[8:11], s81 offen lds
    v_cvt_pk_bf16_f32 v109, v42, -v43
    v_mul_f32 v40, v42, v28
    v_mul_f32 v41, v43, v28
    v_fma_f32 v40, -v43, v29, v40
    v_fmac_f32 v41, v42, v29
    v_cvt_pk_bf16_f32 v110, v40, -v41
    v_mul_f32 v42, v40, v28
    v_mul_f32 v43, v41, v28
    v_fma_f32 v42, -v41, v29, v42
    v_fmac_f32 v43, v40, v29
    v_cvt_pk_bf16_f32 v111, v42, -v43
    s_add_u32 m0, s90, 56576
    s_nop 0
    buffer_load_dwordx4 v3, s[8:11], s81 offen lds
    v_mul_f32 v40, v42, v28
    v_mul_f32 v41, v43, v28
    v_fma_f32 v40, -v43, v29, v40
    v_fmac_f32 v41, v42, v29
    v_cvt_pk_bf16_f32 v112, v40, -v41
    v_mul_f32 v42, v40, v28
    v_mul_f32 v43, v41, v28
    v_fma_f32 v42, -v41, v29, v42
    v_fmac_f32 v43, v40, v29
    v_cvt_pk_bf16_f32 v113, v42, -v43
    s_add_u32 m0, s90, 63744
    s_add_u32 s91, s88, 896
    buffer_load_dwordx4 v4, s[12:15], s91 offen lds
    v_mul_f32 v40, v42, v28
    v_mul_f32 v41, v43, v28
    v_fma_f32 v40, -v43, v29, v40
    v_fmac_f32 v41, v42, v29
    v_cvt_pk_bf16_f32 v114, v40, -v41
    v_mul_f32 v42, v40, v28
    v_mul_f32 v43, v41, v28
    v_fma_f32 v42, -v41, v29, v42
    v_fmac_f32 v43, v40, v29
    v_cvt_pk_bf16_f32 v115, v42, -v43
    s_add_u32 m0, s90, 64768
    s_nop 0
    buffer_load_dwordx4 v5, s[12:15], s91 offen lds
    v_cvt_pk_bf16_f32 v116, v44, -v45
    v_mul_f32 v40, v44, v30
    v_mul_f32 v41, v45, v30
    v_fma_f32 v40, -v45, v31, v40
    v_fmac_f32 v41, v44, v31
    v_cvt_pk_bf16_f32 v117, v40, -v41
    v_mul_f32 v42, v40, v30
    v_mul_f32 v43, v41, v30
    v_fma_f32 v42, -v41, v31, v42
    v_fmac_f32 v43, v40, v31
    v_cvt_pk_bf16_f32 v118, v42, -v43
    s_add_u32 m0, s90, 71936
    s_add_u32 s91, s88, 1792
    buffer_load_dwordx4 v4, s[12:15], s91 offen lds
    v_mul_f32 v40, v42, v30
    v_mul_f32 v41, v43, v30
    v_fma_f32 v40, -v43, v31, v40
    v_fmac_f32 v41, v42, v31
    v_cvt_pk_bf16_f32 v119, v40, -v41
    v_mul_f32 v42, v40, v30
    v_mul_f32 v43, v41, v30
    v_fma_f32 v42, -v41, v31, v42
    v_fmac_f32 v43, v40, v31
    v_cvt_pk_bf16_f32 v120, v42, -v43
    s_add_u32 m0, s90, 72960
    s_nop 0
    buffer_load_dwordx4 v5, s[12:15], s91 offen lds
    v_mul_f32 v46, v44, v36
    v_mul_f32 v47, v45, v36
    v_fma_f32 v46, -v45, v37, v46
    v_fmac_f32 v47, v44, v37
    v_cvt_pk_bf16_f32 v121, v46, -v47
    v_mul_f32 v40, v46, v32
    v_mul_f32 v41, v47, v32
    v_fma_f32 v40, -v47, v33, v40
    v_fmac_f32 v41, v46, v33
    v_cvt_pk_bf16_f32 v122, v40, -v41
    s_waitcnt vmcnt(12)
    s_barrier
    s_mov_b32 s3, 0
    s_waitcnt vmcnt(63)
Lnon_19:
    v_readfirstlane_b32 s46, v200
    s_add_u32 s3, s3, 1
    s_cmp_lg_u32 s46, 0
    s_cbranch_scc1 Lnon_20
    s_cmp_gt_u32 s3, 50000
    s_cbranch_scc1 Lnon_20
    s_sleep 8
    buffer_load_dword v200, off, s[28:31], 0 sc1
    s_waitcnt vmcnt(0)
    s_branch Lnon_19
Lnon_20:
    v_mov_b32 v200, s46
    s_cmp_lg_u32 s42, 0
    s_cbranch_scc1 Lfu_21
    s_mov_b64 exec, 1
    buffer_store_dword v200, off, s[4:7], s59 sc1
    s_mov_b64 exec, -1
Lfu_21:
    s_add_u32 m0, s90, 80128
    s_nop 0
    buffer_load_dwordx4 v2, s[8:11], s82 offen lds
    v_mul_f32 v42, v46, v34
    v_mul_f32 v43, v47, v34
    v_fma_f32 v42, -v47, v35, v42
    v_fmac_f32 v43, v46, v35
    v_cvt_pk_bf16_f32 v123, v42, -v43
    v_mul_f32 v44, v46, v36
    v_mul_f32 v45, v47, v36
    v_fma_f32 v44, -v47, v37, v44
    v_fmac_f32 v45, v46, v37
    v_cvt_pk_bf16_f32 v124, v44, -v45
    s_add_u32 m0, s90, 81152
    s_nop 0
    buffer_load_dwordx4 v3, s[8:11], s82 offen lds
    v_mul_f32 v40, v44, v32
    v_mul_f32 v41, v45, v32
    v_fma_f32 v40, -v45, v33, v40
    v_fmac_f32 v41, v44, v33
    v_cvt_pk_bf16_f32 v125, v40, -v41
    v_mul_f32 v42, v44, v34
    v_mul_f32 v43, v45, v34
    v_fma_f32 v42, -v45, v35, v42
    v_fmac_f32 v43, v44, v35
    v_cvt_pk_bf16_f32 v126, v42, -v43
    v_mul_f32 v46, v44, v36
    s_add_u32 m0, s90, 88320
    s_add_u32 s91, s89, 896
    buffer_load_dwordx4 v4, s[12:15], s91 offen lds
    v_mul_f32 v47, v45, v36
    v_fma_f32 v46, -v45, v37, v46
    v_fmac_f32 v47, v44, v37
    v_cvt_pk_bf16_f32 v127, v46, -v47
    v_mul_f32 v40, v46, v34
    v_mul_f32 v41, v47, v34
    v_fma_f32 v40, -v47, v35, v40
    v_fmac_f32 v41, v46, v35
    v_cvt_pk_bf16_f32 v128, v40, -v41
    v_mul_f32 v44, v46, v36
    s_add_u32 m0, s90, 89344
    s_nop 0
    buffer_load_dwordx4 v5, s[12:15], s91 offen lds
    v_mul_f32 v45, v47, v36
    v_fma_f32 v44, -v47, v37, v44
    v_fmac_f32 v45, v46, v37
    v_cvt_pk_bf16_f32 v129, v44, -v45
    v_mul_f32 v40, v44, v34
    v_mul_f32 v41, v45, v34
    v_fma_f32 v40, -v45, v35, v40
    v_fmac_f32 v41, v44, v35
    v_cvt_pk_bf16_f32 v130, v40, -v41
    v_mul_f32 v46, v44, v36
    s_add_u32 m0, s90, 96512
    s_add_u32 s91, s89, 1792
    buffer_load_dwordx4 v4, s[12:15], s91 offen lds
    v_mul_f32 v47, v45, v36
    v_fma_f32 v46, -v45, v37, v46
    v_fmac_f32 v47, v44, v37
    v_cvt_pk_bf16_f32 v131, v46, -v47
    v_mul_f32 v40, v46, v34
    v_mul_f32 v41, v47, v34
    v_fma_f32 v40, -v47, v35, v40
    v_fmac_f32 v41, v46, v35
    v_cvt_pk_bf16_f32 v132, v40, -v41
    v_mul_f32 v44, v46, v36
    v_mul_f32 v45, v47, v36
    s_add_u32 m0, s90, 97536
    s_nop 0
    buffer_load_dwordx4 v5, s[12:15], s91 offen lds
    v_fma_f32 v44, -v47, v37, v44
    v_fmac_f32 v45, v46, v37
    v_cvt_pk_bf16_f32 v133, v44, -v45
    v_mul_f32 v40, v44, v34
    v_mul_f32 v41, v45, v34
    v_fma_f32 v40, -v45, v35, v40
    v_fmac_f32 v41, v44, v35
    v_cvt_pk_bf16_f32 v134, v40, -v41
    v_cvt_pk_bf16_f32 v135, v34, v35
    v_cvt_pk_bf16_f32 v136, v38, v39
    s_add_u32 m0, s90, 104704
    s_nop 0
    buffer_load_dwordx4 v4, s[12:15], s83 offen lds
    v_mul_f32 v40, v34, v38
    v_mul_f32 v41, v35, v38
    v_fma_f32 v40, -v35, v39, v40
    v_fmac_f32 v41, v34, v39
    v_cvt_pk_bf16_f32 v137, v40, v41
    v_mul_f32 v44, v38, v38
    v_mul_f32 v45, v39, v38
    v_fma_f32 v44, -v39, v39, v44
    v_fmac_f32 v45, v38, v39
    v_cvt_pk_bf16_f32 v138, v44, v45
    s_add_u32 m0, s90, 105728
    s_nop 0
    buffer_load_dwordx4 v5, s[12:15], s83 offen lds
    v_mul_f32 v42, v40, v38
    v_mul_f32 v43, v41, v38
    v_fma_f32 v42, -v41, v39, v42
    v_fmac_f32 v43, v40, v39
    v_cvt_pk_bf16_f32 v139, v42, v43
    v_mul_f32 v46, v44, v38
    v_mul_f32 v47, v45, v38
    v_fma_f32 v46, -v45, v39, v46
    v_fmac_f32 v47, v44, v39
    v_cvt_pk_bf16_f32 v140, v46, v47
    v_mul_f32 v40, v42, v38
    s_waitcnt vmcnt(14)
    s_barrier
    s_add_u32 m0, s90, 112896
    s_nop 0
    buffer_load_dwordx4 v4, s[12:15], s84 offen lds
    v_mul_f32 v41, v43, v38
    v_fma_f32 v40, -v43, v39, v40
    v_fmac_f32 v41, v42, v39
    v_cvt_pk_bf16_f32 v141, v40, v41
    v_mul_f32 v44, v46, v38
    v_mul_f32 v45, v47, v38
    v_fma_f32 v44, -v47, v39, v44
    v_fmac_f32 v45, v46, v39
    v_cvt_pk_bf16_f32 v142, v44, v45
    v_mul_f32 v42, v40, v38
    s_add_u32 m0, s90, 113920
    s_nop 0
    buffer_load_dwordx4 v5, s[12:15], s84 offen lds
    v_mul_f32 v43, v41, v38
    v_fma_f32 v42, -v41, v39, v42
    v_fmac_f32 v43, v40, v39
    v_cvt_pk_bf16_f32 v143, v42, v43
    v_mul_f32 v46, v44, v38
    v_mul_f32 v47, v45, v38
    v_fma_f32 v46, -v45, v39, v46
    v_fmac_f32 v47, v44, v39
    v_cvt_pk_bf16_f32 v144, v46, v47
    v_mul_f32 v40, v42, v38
    s_add_u32 m0, s90, 121088
    s_nop 0
    buffer_load_dwordx4 v4, s[12:15], s85 offen lds
    v_mul_f32 v41, v43, v38
    v_fma_f32 v40, -v43, v39, v40
    v_fmac_f32 v41, v42, v39
    v_cvt_pk_bf16_f32 v145, v40, v41
    v_mul_f32 v44, v46, v38
    v_mul_f32 v45, v47, v38
    v_fma_f32 v44, -v47, v39, v44
    v_fmac_f32 v45, v46, v39
    v_cvt_pk_bf16_f32 v146, v44, v45
    v_mul_f32 v42, v40, v38
    v_mul_f32 v43, v41, v38
    s_add_u32 m0, s90, 122112
    s_nop 0
    buffer_load_dwordx4 v5, s[12:15], s85 offen lds
    v_fma_f32 v42, -v41, v39, v42
    v_fmac_f32 v43, v40, v39
    v_cvt_pk_bf16_f32 v147, v42, v43
    v_mul_f32 v46, v44, v38
    v_mul_f32 v47, v45, v38
    v_fma_f32 v46, -v45, v39, v46
    v_fmac_f32 v47, v44, v39
    v_cvt_pk_bf16_f32 v148, v46, v47
    v_mul_f32 v40, v42, v38
    v_mul_f32 v41, v43, v38
    s_add_u32 m0, s90, 129280
    s_nop 0
    buffer_load_dwordx4 v4, s[12:15], s86 offen lds
    v_fma_f32 v40, -v43, v39, v40
    v_fmac_f32 v41, v42, v39
    v_cvt_pk_bf16_f32 v149, v40, v41
    v_mul_f32 v44, v46, v38
    v_mul_f32 v45, v47, v38
    v_fma_f32 v44, -v47, v39, v44
    v_fmac_f32 v45, v46, v39
    v_cvt_pk_bf16_f32 v150, v44, v45
    v_mul_f32 v42, v40, v38
    v_mul_f32 v43, v41, v38
    s_add_u32 m0, s90, 130304
    s_nop 0
    buffer_load_dwordx4 v5, s[12:15], s86 offen lds
    v_fma_f32 v42, -v41, v39, v42
    v_fmac_f32 v43, v40, v39
    v_cvt_pk_bf16_f32 v151, v42, v43
    v_mul_f32 v46, v44, v38
    v_mul_f32 v47, v45, v38
    v_fma_f32 v46, -v45, v39, v46
    v_fmac_f32 v47, v44, v39
    v_cvt_pk_bf16_f32 v152, v46, v47
    v_mul_f32 v40, v42, v38
    v_mul_f32 v41, v43, v38
    v_fma_f32 v40, -v43, v39, v40
    s_add_u32 m0, s90, 137472
    s_nop 0
    buffer_load_dwordx4 v4, s[12:15], s87 offen lds
    v_fmac_f32 v41, v42, v39
    v_cvt_pk_bf16_f32 v153, v40, v41
    v_mul_f32 v44, v46, v38
    v_mul_f32 v45, v47, v38
    v_fma_f32 v44, -v47, v39, v44
    v_fmac_f32 v45, v46, v39
    v_cvt_pk_bf16_f32 v154, v44, v45
    v_mul_f32 v42, v40, v38
    v_mul_f32 v43, v41, v38
    v_fma_f32 v42, -v41, v39, v42
    s_add_u32 m0, s90, 138496
    s_nop 0
    buffer_load_dwordx4 v5, s[12:15], s87 offen lds
    v_fmac_f32 v43, v40, v39
    v_cvt_pk_bf16_f32 v155, v42, v43
    v_mul_f32 v46, v44, v38
    v_mul_f32 v47, v45, v38
    v_fma_f32 v46, -v45, v39, v46
    v_fmac_f32 v47, v44, v39
    v_cvt_pk_bf16_f32 v156, v46, v47
    v_mul_f32 v40, v42, v38
    v_mul_f32 v41, v43, v38
    v_fma_f32 v40, -v43, v39, v40
    s_waitcnt vmcnt(16)
    s_barrier
    s_add_u32 m0, s90, 145664
    s_nop 0
    buffer_load_dwordx4 v4, s[12:15], s88 offen lds
    v_fmac_f32 v41, v42, v39
    v_cvt_pk_bf16_f32 v157, v40, v41
    v_mul_f32 v44, v46, v38
    v_mul_f32 v45, v47, v38
    v_fma_f32 v44, -v47, v39, v44
    v_fmac_f32 v45, v46, v39
    v_cvt_pk_bf16_f32 v158, v44, v45
    v_mul_f32 v42, v40, v38
    v_mul_f32 v43, v41, v38
    v_fma_f32 v42, -v41, v39, v42
    v_fmac_f32 v43, v40, v39
    s_add_u32 m0, s90, 146688
    s_nop 0
    buffer_load_dwordx4 v5, s[12:15], s88 offen lds
    v_cvt_pk_bf16_f32 v159, v42, v43
    v_mul_f32 v46, v44, v38
    v_mul_f32 v47, v45, v38
    v_fma_f32 v46, -v45, v39, v46
    v_fmac_f32 v47, v44, v39
    v_cvt_pk_bf16_f32 v160, v46, v47
    v_mul_f32 v40, v42, v38
    v_mul_f32 v41, v43, v38
    v_fma_f32 v40, -v43, v39, v40
    v_fmac_f32 v41, v42, v39
    s_add_u32 m0, s90, 153856
    s_nop 0
    buffer_load_dwordx4 v4, s[12:15], s89 offen lds
    v_cvt_pk_bf16_f32 v161, v40, v41
    v_mul_f32 v44, v46, v38
    v_mul_f32 v45, v47, v38
    v_fma_f32 v44, -v47, v39, v44
    v_fmac_f32 v45, v46, v39
    v_cvt_pk_bf16_f32 v162, v44, v45
    v_mul_f32 v42, v40, v38
    v_mul_f32 v43, v41, v38
    v_fma_f32 v42, -v41, v39, v42
    v_fmac_f32 v43, v40, v39
    s_add_u32 m0, s90, 154880
    s_nop 0
    buffer_load_dwordx4 v5, s[12:15], s89 offen lds
    v_cvt_pk_bf16_f32 v163, v42, v43
    v_mul_f32 v46, v44, v38
    v_mul_f32 v47, v45, v38
    v_fma_f32 v46, -v45, v39, v46
    v_fmac_f32 v47, v44, v39
    v_cvt_pk_bf16_f32 v164, v46, v47
    v_mul_f32 v40, v42, v38
    v_mul_f32 v41, v43, v38
    v_fma_f32 v40, -v43, v39, v40
    v_fmac_f32 v41, v42, v39
    v_cvt_pk_bf16_f32 v165, v40, v41
    s_waitcnt vmcnt(14)
    s_barrier
    s_lshl_b32 s56, s42, 2
    s_add_u32 s56, s56, 162064
    v_mov_b32 v9, s56
    v_xor_b32 v10, 4, v9
    v_mov_b32 v11, 162048
    v_lshlrev_b32 v12, 4, v0
    v_mov_b32 v13, v176
    s_xor_b32 s56, s42, 1
    s_mul_i32 s56, s56, 8704
    s_add_u32 s56, s56, 12544
    v_add_u32 v14, s56, v12
    v_and_b32 v6, 31, v0
    v_lshrrev_b32 v7, 5, v0
    v_lshlrev_b32 v15, 6, v6
    v_lshl_add_u32 v15, v7, 5, v15
    v_add_u32 v15, s45, v15
    v_mul_u32_u24 v1, 1792, v6
    v_lshl_add_u32 v1, v7, 5, v1
    v_mul_u32_u24 v4, 272, v6
    v_lshl_add_u32 v4, v7, 6, v4
    v_add_u32 v4, s45, v4
    v_bfe_u32 v6, v0, 2, 2
    v_mad_u32_u24 v6, v7, 7, v6
    v_lshlrev_b32 v2, 7, v6
    v_and_b32 v6, 1, v0
    v_lshl_add_u32 v2, v6, 5, v2
    v_lshrrev_b32 v16, 1, v0
    v_lshlrev_b32 v16, 12, v16
    v_lshl_add_u32 v16, v6, 4, v16
    s_waitcnt vmcnt(10)
    s_barrier
    s_mov_b32 exec_hi, 0
    s_mov_b32 exec_lo, s52
    buffer_load_dword v207, v203, s[4:7], 0 offen sc1
    s_mov_b64 exec, -1
    v_lshlrev_b32 v5, 4, v6
    v_lshrrev_b32 v5, v5, s46
    v_lshlrev_b32 v5, 16, v5
    v_bfe_u32 v6, v0, 4, 1
    v_lshl_add_u32 v2, v6, 4, v2
    v_bfe_u32 v6, v0, 1, 1
    v_lshl_add_u32 v2, v6, 3, v2
    s_mul_i32 s56, s44, 3584
    s_add_u32 s56, s56, 96512
    v_add_u32 v2, s56, v2
    v_lshlrev_b32 v3, 12, v0
    v_mov_b32 v17, v177
    v_mov_b32 v18, v178
    v_mov_b32 v19, v179
    v_lshrrev_b32 v6, 3, v0
    v_and_b32 v7, 7, v0
    v_lshlrev_b32 v7, 4, v7
    v_mul_u32_u24 v20, 1792, v6
    v_add_u32 v20, v20, v7
    v_mul_u32_u24 v25, 272, v6
    v_lshl_add_u32 v25, v7, 1, v25
    s_mul_i32 s56, s44, 4352
    s_add_u32 s56, s56, s61
    v_add_u32 v25, s56, v25
    v_mul_u32_u24 v22, 896, v6
    v_add_u32 v22, v22, v7
    v_lshlrev_b32 v23, 3, v0
    v_add_u32 v23, 153856, v23
    v_add_u32 v24, 114688, v203
    s_waitcnt vmcnt(1)
    s_barrier
    s_mov_b32 m0, s45
    s_setprio 1
    ds_write_addtid_b32 v48 offset:0
    ds_write_addtid_b32 v49 offset:272
    ds_write_addtid_b32 v50 offset:544
    ds_write_addtid_b32 v51 offset:816
    ds_write_addtid_b32 v52 offset:2176
    ds_write_addtid_b32 v53 offset:2448
    ds_write_addtid_b32 v54 offset:2720
    ds_write_addtid_b32 v55 offset:2992
    ds_write_addtid_b32 v56 offset:1088
    ds_write_addtid_b32 v56 offset:1360
    ds_write_addtid_b32 v57 offset:1632
    ds_write_addtid_b32 v58 offset:1904
    ds_write_addtid_b32 v58 offset:3264
    ds_write_addtid_b32 v58 offset:3536
    ds_write_addtid_b32 v59 offset:3808
    ds_write_addtid_b32 v60 offset:4080
    ds_write_addtid_b32 v61 offset:4352
    ds_write_addtid_b32 v62 offset:4624
    ds_write_addtid_b32 v63 offset:4896
    ds_write_addtid_b32 v64 offset:5440
    ds_write_addtid_b32 v65 offset:5712
    ds_write_addtid_b32 v66 offset:5984
    ds_write_addtid_b32 v67 offset:5168
    ds_write_addtid_b32 v68 offset:6528
    ds_write_addtid_b32 v69 offset:6256
    ds_write_addtid_b32 v70 offset:7616
    ds_write_addtid_b32 v71 offset:6800
    ds_write_addtid_b32 v72 offset:7072
    ds_write_addtid_b32 v73 offset:7888
    ds_write_addtid_b32 v74 offset:8160
    ds_read_b128 v[216:219], v21 offset:0
    ds_read_b128 v[220:223], v21 offset:32
    ds_read_b128 v[224:227], v21 offset:64
    ds_read_b128 v[228:231], v21 offset:96
    ds_read_b128 v[232:235], v21 offset:128
    ds_read_b128 v[236:239], v21 offset:160
    ds_read_b128 v[240:243], v21 offset:192
    ds_read_b128 v[244:247], v21 offset:224
    ds_write_addtid_b32 v27 offset:0
    ds_write_addtid_b32 v75 offset:272
    ds_write_addtid_b32 v76 offset:544
    ds_write_addtid_b32 v77 offset:816
    ds_write_addtid_b32 v78 offset:1088
    ds_write_addtid_b32 v79 offset:1360
    ds_write_addtid_b32 v80 offset:1632
    ds_write_addtid_b32 v81 offset:1904
    ds_write_addtid_b32 v82 offset:2176
    ds_write_addtid_b32 v83 offset:2448
    ds_write_addtid_b32 v84 offset:2720
    ds_write_addtid_b32 v85 offset:2992
    ds_write_addtid_b32 v86 offset:3264
    ds_write_addtid_b32 v87 offset:3536
    ds_write_addtid_b32 v88 offset:3808
    ds_write_addtid_b32 v89 offset:4080
    ds_write_addtid_b32 v90 offset:4352
    ds_write_addtid_b32 v91 offset:4624
    ds_write_addtid_b32 v92 offset:4896
    ds_write_addtid_b32 v93 offset:5168
    ds_write_addtid_b32 v94 offset:5440
    ds_write_addtid_b32 v95 offset:5712
    ds_write_addtid_b32 v96 offset:5984
    ds_write_addtid_b32 v97 offset:6256
    ds_write_addtid_b32 v98 offset:6528
    ds_write_addtid_b32 v99 offset:6800
    ds_write_addtid_b32 v100 offset:7072
    ds_write_addtid_b32 v101 offset:7344
    ds_write_addtid_b32 v102 offset:7616
    ds_write_addtid_b32 v103 offset:7888
    ds_write_addtid_b32 v104 offset:8160
    ds_write_addtid_b32 v105 offset:8432
    ds_read_b128 v[48:51], v21 offset:0
    ds_read_b128 v[52:55], v21 offset:32
    ds_read_b128 v[56:59], v21 offset:64
    ds_read_b128 v[60:63], v21 offset:96
    ds_read_b128 v[64:67], v21 offset:128
    ds_read_b128 v[68:71], v21 offset:160
    ds_read_b128 v[72:75], v21 offset:192
    ds_read_b128 v[76:79], v21 offset:224
    s_mov_b32 exec_hi, 0
    s_mov_b32 exec_lo, s52
    s_waitcnt vmcnt(0)
    v_cmp_ne_u32 vcc, s46, v207
    s_cbranch_vccz Lok_22
    s_mov_b32 s3, 0
Lpoll_24:
    buffer_load_dword v207, v203, s[4:7], 0 offen sc1
    s_add_u32 s3, s3, 1
    s_cmp_gt_u32 s3, 50000
    s_cbranch_scc1 Lpoll_25
    s_waitcnt vmcnt(0)
    v_cmp_ne_u32 vcc, s46, v207
    s_cbranch_vccz Lpoll_25
    s_mov_b64 exec, vcc
    s_bcnt1_i32_b64 s63, vcc
    s_cmp_le_u32 s63, 0
    s_cbranch_scc1 Lpoll_24
    s_sleep 4
    s_branch Lpoll_24
Lpoll_25:
    s_mov_b64 exec, -1
Lok_22:
    s_mov_b64 exec, -1
    buffer_load_dwordx2 v[186:187], v12, s[4:7], s57 offen offset:0 sc1
    buffer_load_dwordx4 v[188:191], v12, s[4:7], s57 offen offset:8 sc1
    buffer_load_dwordx2 v[194:195], v12, s[4:7], s57 offen offset:1024 sc1
    buffer_load_dwordx4 v[196:199], v12, s[4:7], s57 offen offset:1032 sc1
    s_sub_u32 s55, s2, 32
    s_lshl_b32 s56, s42, 5
    s_add_u32 s56, s56, s55
    s_lshl_b32 s55, s55, 7
    s_add_u32 s55, s55, 12840960
    s_cmp_ge_u32 s56, 32
    s_cbranch_scc1 Lh_23
    s_mov_b64 exec, 1
    buffer_store_dword v200, off, s[4:7], s55 sc1
    s_mov_b64 exec, -1
Lh_23:
    s_waitcnt lgkmcnt(0)
    v_mfma_f32_32x32x16_bf16 v[84:99], v[216:219], v[48:51], 0
    ds_write_addtid_b32 v108 offset:0
    ds_write_addtid_b32 v109 offset:272
    ds_write_addtid_b32 v110 offset:544
    ds_write_addtid_b32 v111 offset:816
    v_mfma_f32_32x32x16_bf16 v[84:99], v[220:223], v[52:55], v[84:99]
    ds_write_addtid_b32 v112 offset:2176
    ds_write_addtid_b32 v113 offset:2448
    ds_write_addtid_b32 v114 offset:2720
    ds_write_addtid_b32 v115 offset:2992
    v_mfma_f32_32x32x16_bf16 v[84:99], v[224:227], v[56:59], v[84:99]
    ds_write_addtid_b32 v116 offset:1088
    ds_write_addtid_b32 v116 offset:1360
    ds_write_addtid_b32 v117 offset:1632
    ds_write_addtid_b32 v118 offset:1904
    v_mfma_f32_32x32x16_bf16 v[84:99], v[228:231], v[60:63], v[84:99]
    ds_write_addtid_b32 v118 offset:3264
    ds_write_addtid_b32 v118 offset:3536
    ds_write_addtid_b32 v119 offset:3808
    ds_write_addtid_b32 v120 offset:4080
    v_mfma_f32_32x32x16_bf16 v[84:99], v[232:235], v[64:67], v[84:99]
    ds_write_addtid_b32 v121 offset:4352
    ds_write_addtid_b32 v122 offset:4624
    ds_write_addtid_b32 v123 offset:4896
    ds_write_addtid_b32 v124 offset:5440
    v_mfma_f32_32x32x16_bf16 v[84:99], v[236:239], v[68:71], v[84:99]
    ds_write_addtid_b32 v125 offset:5712
    ds_write_addtid_b32 v126 offset:5984
    ds_write_addtid_b32 v127 offset:5168
    ds_write_addtid_b32 v128 offset:6528
    v_mfma_f32_32x32x16_bf16 v[84:99], v[240:243], v[72:75], v[84:99]
    ds_write_addtid_b32 v129 offset:6256
    ds_write_addtid_b32 v130 offset:7616
    ds_write_addtid_b32 v131 offset:6800
    ds_write_addtid_b32 v132 offset:7072
    v_mfma_f32_32x32x16_bf16 v[84:99], v[244:247], v[76:79], v[84:99]
    ds_write_addtid_b32 v133 offset:7888
    ds_write_addtid_b32 v134 offset:8160
    ds_read_b128 v[216:219], v21 offset:0
    ds_read_b128 v[220:223], v21 offset:32
    ds_read_b128 v[224:227], v21 offset:64
    ds_read_b128 v[228:231], v21 offset:96
    ds_read_b128 v[232:235], v21 offset:128
    ds_read_b128 v[236:239], v21 offset:160
    ds_read_b128 v[240:243], v21 offset:192
    ds_read_b128 v[244:247], v21 offset:224
    ds_write_addtid_b32 v27 offset:0
    ds_write_addtid_b32 v135 offset:272
    ds_write_addtid_b32 v136 offset:544
    ds_write_addtid_b32 v137 offset:816
    ds_write_addtid_b32 v138 offset:1088
    ds_write_addtid_b32 v139 offset:1360
    ds_write_addtid_b32 v140 offset:1632
    ds_write_addtid_b32 v141 offset:1904
    ds_write_addtid_b32 v142 offset:2176
    ds_write_addtid_b32 v143 offset:2448
    ds_write_addtid_b32 v144 offset:2720
    ds_write_addtid_b32 v145 offset:2992
    ds_write_addtid_b32 v146 offset:3264
    ds_write_addtid_b32 v147 offset:3536
    ds_write_addtid_b32 v148 offset:3808
    ds_write_addtid_b32 v149 offset:4080
    ds_write_addtid_b32 v150 offset:4352
    ds_write_addtid_b32 v151 offset:4624
    ds_write_addtid_b32 v152 offset:4896
    ds_write_addtid_b32 v153 offset:5168
    ds_write_addtid_b32 v154 offset:5440
    ds_write_addtid_b32 v155 offset:5712
    ds_write_addtid_b32 v156 offset:5984
    ds_write_addtid_b32 v157 offset:6256
    ds_write_addtid_b32 v158 offset:6528
    ds_write_addtid_b32 v159 offset:6800
    ds_write_addtid_b32 v160 offset:7072
    ds_write_addtid_b32 v161 offset:7344
    ds_write_addtid_b32 v162 offset:7616
    ds_write_addtid_b32 v163 offset:7888
    ds_write_addtid_b32 v164 offset:8160
    ds_write_addtid_b32 v165 offset:8432
    ds_read_b128 v[108:111], v21 offset:0
    ds_read_b128 v[112:115], v21 offset:32
    ds_read_b128 v[116:119], v21 offset:64
    ds_read_b128 v[120:123], v21 offset:96
    ds_read_b128 v[124:127], v21 offset:128
    ds_read_b128 v[128:131], v21 offset:160
    ds_read_b128 v[132:135], v21 offset:192
    ds_read_b128 v[136:139], v21 offset:224
    s_waitcnt vmcnt(0)
    v_alignbit_b32 v48, v188, v187, 16
    v_alignbit_b32 v49, v189, v188, 16
    v_alignbit_b32 v50, v190, v189, 16
    v_alignbit_b32 v51, v191, v190, 16
    v_mov_b32 v52, v187
    v_mov_b32 v53, v188
    v_mov_b32 v54, v189
    v_mov_b32 v55, v190
    v_alignbit_b32 v56, v187, v186, 16
    v_mov_b32 v57, v48
    v_mov_b32 v58, v49
    v_mov_b32 v59, v50
    v_alignbit_b32 v60, v196, v195, 16
    v_alignbit_b32 v61, v197, v196, 16
    v_alignbit_b32 v62, v198, v197, 16
    v_alignbit_b32 v63, v199, v198, 16
    v_mov_b32 v64, v195
    v_mov_b32 v65, v196
    v_mov_b32 v66, v197
    v_mov_b32 v67, v198
    v_alignbit_b32 v68, v195, v194, 16
    v_mov_b32 v69, v60
    v_mov_b32 v70, v61
    v_mov_b32 v71, v62
    s_waitcnt lgkmcnt(0)
    v_mfma_f32_32x32x16_bf16 v[84:99], v[216:219], v[108:111], v[84:99]
    v_mfma_f32_32x32x16_bf16 v[84:99], v[220:223], v[112:115], v[84:99]
    v_mfma_f32_32x32x16_bf16 v[84:99], v[224:227], v[116:119], v[84:99]
    v_mfma_f32_32x32x16_bf16 v[84:99], v[228:231], v[120:123], v[84:99]
    v_mfma_f32_32x32x16_bf16 v[84:99], v[232:235], v[124:127], v[84:99]
    v_mfma_f32_32x32x16_bf16 v[84:99], v[236:239], v[128:131], v[84:99]
    v_mfma_f32_32x32x16_bf16 v[84:99], v[240:243], v[132:135], v[84:99]
    v_mfma_f32_32x32x16_bf16 v[84:99], v[244:247], v[136:139], v[84:99]
    v_mfma_f32_32x32x16_bf16 v[216:231], v[252:255], v[252:255], 0
    v_mfma_f32_32x32x16_bf16 v[232:247], v[252:255], v[252:255], 0
    s_nop 9
    ds_write_b128 v13, v[84:87] offset:0
    ds_write_b128 v13, v[88:91] offset:1024
    ds_write_b128 v13, v[92:95] offset:2048
    ds_write_b128 v13, v[96:99] offset:3072
    v_mov_b32 v8, 1
    s_mov_b64 exec, 1
    ds_write_b32 v9, v8
    s_mov_b64 exec, -1
Lpw_26:
    ds_read_b32 v8, v10 offset:0
    s_waitcnt lgkmcnt(0)
    v_readfirstlane_b32 s3, v8
    s_cmp_ge_u32 s3, 1
    s_cbranch_scc1 Lpw_27
    s_branch Lpw_26
Lpw_27:
    ds_read_b128 v[28:31], v206 offset:0
    ds_read_b128 v[32:35], v206 offset:1024
    ds_read_b128 v[36:39], v206 offset:8704
    ds_read_b128 v[40:43], v206 offset:9728
    v_mov_b32 v8, 2
    s_mov_b64 exec, 1
    ds_write_b32 v9, v8
    s_mov_b64 exec, -1
    s_waitcnt lgkmcnt(0)
    v_add_f32 v28, v28, v36
    v_add_f32 v29, v29, v37
    v_add_f32 v30, v30, v38
    v_add_f32 v31, v31, v39
    v_add_f32 v32, v32, v40
    v_add_f32 v33, v33, v41
    v_add_f32 v34, v34, v42
    v_add_f32 v35, v35, v43
    s_cmp_eq_u32 s44, 0
    s_cbranch_scc0 Lkx_28
    s_mov_b64 exec, 1
    v_add_f32 v28, s49, v28
    s_mov_b64 exec, -1
    v_cvt_pk_bf16_f32 v100, v35, v34
    v_cvt_pk_bf16_f32 v101, v33, v32
    v_cvt_pk_bf16_f32 v102, v31, v30
    v_cvt_pk_bf16_f32 v103, v29, v28
    ds_write_b128 v202, v[100:103] offset:512
    ds_write_b128 v202, v[252:255] offset:256
    ds_write_b128 v202, v[252:255] offset:0
    s_branch Lkx_29
Lkx_28:
    s_mov_b32 vcc_lo, 0x55555555
    s_mov_b32 vcc_hi, 0x55555555
    v_cvt_pk_bf16_f32 v100, v30, v30
    v_cvt_pk_bf16_f32 v101, v29, v29
    v_cvt_pk_bf16_f32 v102, v29, v28
    v_cvt_pk_bf16_f32 v103, v28, v28
    v_cndmask_b32 v6, v32, v31, vcc
    v_cvt_pk_bf16_f32 v104, v32, v32
    v_cvt_pk_bf16_f32 v105, v32, v6
    v_cvt_pk_bf16_f32 v106, v31, v31
    v_cvt_pk_bf16_f32 v107, v31, v31
    v_cndmask_b32 v6, v34, v33, vcc
    v_cvt_pk_bf16_f32 v108, v34, v34
    v_cvt_pk_bf16_f32 v109, v34, v6
    v_cvt_pk_bf16_f32 v110, v33, v33
    v_cvt_pk_bf16_f32 v111, v33, v33
    ds_write_b128 v202, v[100:103] offset:768
    ds_write_b128 v202, v[104:107] offset:1024
    ds_write_b128 v202, v[108:111] offset:1280
Lkx_29:
Lpw_30:
    ds_read_b32 v8, v10 offset:0
    s_waitcnt lgkmcnt(0)
    v_readfirstlane_b32 s3, v8
    s_cmp_ge_u32 s3, 2
    s_cbranch_scc1 Lpw_31
    s_branch Lpw_30
Lpw_31:
    ds_write_b32 v201, v252
    ds_write_b128 v206, v[188:191] offset:64
    ds_write_b128 v206, v[48:51] offset:4224
    ds_write_b128 v206, v[52:55] offset:8384
    ds_write_b128 v206, v[56:59] offset:12544
    ds_write_b128 v206, v[196:199] offset:1088
    ds_write_b128 v206, v[60:63] offset:5248
    ds_write_b128 v206, v[64:67] offset:9408
    ds_write_b128 v206, v[68:71] offset:13568
    v_mov_b32 v8, 3
    s_mov_b64 exec, 1
    ds_write_b32 v9, v8
    s_mov_b64 exec, -1
Lpw_32:
    ds_read_b32 v8, v10 offset:0
    s_waitcnt lgkmcnt(0)
    v_readfirstlane_b32 s3, v8
    s_cmp_ge_u32 s3, 3
    s_cbranch_scc1 Lpw_33
    s_branch Lpw_32
Lpw_33:
    s_setprio 0
    ds_read_b64 v[120:121], v204 offset:32
    ds_read_b64 v[122:123], v204 offset:40
    ds_read_b128 v[136:139], v205 offset:32
    ds_read_b128 v[144:147], v205 offset:544
    ds_read_b64 v[128:129], v204 offset:2080
    ds_read_b64 v[130:131], v204 offset:2088
    ds_read_b64 v[124:125], v204 offset:0
    ds_read_b64 v[126:127], v204 offset:8
    ds_read_b128 v[140:143], v205 offset:3168
    ds_read_b128 v[148:151], v205 offset:3680
    ds_read_b64 v[132:133], v204 offset:2048
    ds_read_b64 v[134:135], v204 offset:2056
    s_mov_b32 s54, 0
Lcv_34:
    s_waitcnt lgkmcnt(0)
    v_mfma_f32_32x32x16_bf16 v[216:231], v[120:123], v[136:139], v[216:231]
    ds_read_b64 v[152:153], v204 offset:96
    ds_read_b64 v[154:155], v204 offset:104
    ds_read_b128 v[168:171], v205 offset:16
    v_mfma_f32_32x32x16_bf16 v[232:247], v[120:123], v[144:147], v[232:247]
    ds_read_b128 v[176:179], v205 offset:528
    ds_read_b64 v[160:161], v204 offset:2144
    ds_read_b64 v[162:163], v204 offset:2152
    v_mfma_f32_32x32x16_bf16 v[232:247], v[128:131], v[136:139], v[232:247]
    ds_read_b64 v[156:157], v204 offset:64
    ds_read_b64 v[158:159], v204 offset:72
    ds_read_b128 v[172:175], v205 offset:3152
    v_mfma_f32_32x32x16_bf16 v[216:231], v[124:127], v[140:143], v[216:231]
    ds_read_b128 v[180:183], v205 offset:3664
    ds_read_b64 v[164:165], v204 offset:2112
    ds_read_b64 v[166:167], v204 offset:2120
    v_mfma_f32_32x32x16_bf16 v[232:247], v[124:127], v[148:151], v[232:247]
    v_mfma_f32_32x32x16_bf16 v[232:247], v[132:135], v[140:143], v[232:247]
    s_waitcnt lgkmcnt(0)
    v_mfma_f32_32x32x16_bf16 v[216:231], v[152:155], v[168:171], v[216:231]
    ds_read_b64 v[120:121], v204 offset:160
    ds_read_b64 v[122:123], v204 offset:168
    ds_read_b128 v[136:139], v205 offset:0
    v_mfma_f32_32x32x16_bf16 v[232:247], v[152:155], v[176:179], v[232:247]
    ds_read_b128 v[144:147], v205 offset:512
    ds_read_b64 v[128:129], v204 offset:2208
    ds_read_b64 v[130:131], v204 offset:2216
    v_mfma_f32_32x32x16_bf16 v[232:247], v[160:163], v[168:171], v[232:247]
    ds_read_b64 v[124:125], v204 offset:128
    ds_read_b64 v[126:127], v204 offset:136
    ds_read_b128 v[140:143], v205 offset:3136
    v_mfma_f32_32x32x16_bf16 v[216:231], v[156:159], v[172:175], v[216:231]
    ds_read_b128 v[148:151], v205 offset:3648
    ds_read_b64 v[132:133], v204 offset:2176
    ds_read_b64 v[134:135], v204 offset:2184
    v_mfma_f32_32x32x16_bf16 v[232:247], v[156:159], v[180:183], v[232:247]
    v_add_u32 v204, 128, v204
    v_subrev_u32 v205, 32, v205
    s_add_u32 s54, s54, 1
    v_mfma_f32_32x32x16_bf16 v[232:247], v[164:167], v[172:175], v[232:247]
    s_cmp_lt_u32 s54, 8
    s_cbranch_scc1 Lcv_34
    s_setprio 3
    v_mov_b32 v8, 4
    s_mov_b64 exec, 1
    ds_write_b32 v9, v8
    s_mov_b64 exec, -1
    s_lshl_b32 s50, s58, 12
    s_lshl_b32 s55, s44, 11
    s_add_u32 s50, s50, s55
    s_add_u32 s50, s50, 10485760
    s_add_u32 s59, s59, 114688
Lpw_35:
    ds_read_b32 v8, v10 offset:0
    s_waitcnt lgkmcnt(0)
    v_readfirstlane_b32 s3, v8
    s_cmp_ge_u32 s3, 4
    s_cbranch_scc1 Lpw_36
    s_sleep 2
    s_branch Lpw_35
Lpw_36:
    s_cmp_eq_u32 s44, 0
    s_cbranch_scc1 Lcx_37
    ds_write_b128 v13, v[216:219] offset:0
    ds_write_b128 v13, v[220:223] offset:1024
    ds_write_b128 v13, v[224:227] offset:2048
    ds_write_b128 v13, v[228:231] offset:3072
    v_mov_b32 v8, 5
    s_mov_b64 exec, 1
    ds_write_b32 v9, v8
    s_mov_b64 exec, -1
Lpw_39:
    ds_read_b32 v8, v10 offset:0
    s_waitcnt lgkmcnt(0)
    v_readfirstlane_b32 s3, v8
    s_cmp_ge_u32 s3, 5
    s_cbranch_scc1 Lpw_40
    s_sleep 1
    s_branch Lpw_39
Lpw_40:
    ds_read_b128 v[48:51], v14 offset:0
    ds_read_b128 v[52:55], v14 offset:1024
    ds_read_b128 v[56:59], v14 offset:2048
    ds_read_b128 v[60:63], v14 offset:3072
    s_waitcnt lgkmcnt(0)
    v_add_f32 v48, v48, v232
    v_add_f32 v49, v49, v233
    v_add_f32 v50, v50, v234
    v_add_f32 v51, v51, v235
    v_add_f32 v52, v52, v236
    v_add_f32 v53, v53, v237
    v_add_f32 v54, v54, v238
    v_add_f32 v55, v55, v239
    v_add_f32 v56, v56, v240
    v_add_f32 v57, v57, v241
    v_add_f32 v58, v58, v242
    v_add_f32 v59, v59, v243
    v_add_f32 v60, v60, v244
    v_add_f32 v61, v61, v245
    v_add_f32 v62, v62, v246
    v_add_f32 v63, v63, v247
    s_branch Lcx_38
Lcx_37:
    ds_write_b128 v13, v[232:235] offset:0
    ds_write_b128 v13, v[236:239] offset:1024
    ds_write_b128 v13, v[240:243] offset:2048
    ds_write_b128 v13, v[244:247] offset:3072
    v_mov_b32 v8, 5
    s_mov_b64 exec, 1
    ds_write_b32 v9, v8
    s_mov_b64 exec, -1
Lpw_41:
    ds_read_b32 v8, v10 offset:0
    s_waitcnt lgkmcnt(0)
    v_readfirstlane_b32 s3, v8
    s_cmp_ge_u32 s3, 5
    s_cbranch_scc1 Lpw_42
    s_sleep 1
    s_branch Lpw_41
Lpw_42:
    ds_read_b128 v[48:51], v14 offset:0
    ds_read_b128 v[52:55], v14 offset:1024
    ds_read_b128 v[56:59], v14 offset:2048
    ds_read_b128 v[60:63], v14 offset:3072
    s_waitcnt lgkmcnt(0)
    v_add_f32 v48, v48, v216
    v_add_f32 v49, v49, v217
    v_add_f32 v50, v50, v218
    v_add_f32 v51, v51, v219
    v_add_f32 v52, v52, v220
    v_add_f32 v53, v53, v221
    v_add_f32 v54, v54, v222
    v_add_f32 v55, v55, v223
    v_add_f32 v56, v56, v224
    v_add_f32 v57, v57, v225
    v_add_f32 v58, v58, v226
    v_add_f32 v59, v59, v227
    v_add_f32 v60, v60, v228
    v_add_f32 v61, v61, v229
    v_add_f32 v62, v62, v230
    v_add_f32 v63, v63, v231
Lcx_38:
    v_cvt_pk_bf16_f32 v48, v48, v49
    v_cvt_pk_bf16_f32 v49, v50, v51
    v_cvt_pk_bf16_f32 v50, v52, v53
    v_cvt_pk_bf16_f32 v51, v54, v55
    v_cvt_pk_bf16_f32 v52, v56, v57
    v_cvt_pk_bf16_f32 v53, v58, v59
    v_cvt_pk_bf16_f32 v54, v60, v61
    v_cvt_pk_bf16_f32 v55, v62, v63
    ds_write_b128 v15, v[48:51] offset:4096
    ds_write_b128 v15, v[52:55] offset:4112
    ds_read_b128 v[56:59], v13 offset:4096
    ds_read_b128 v[60:63], v13 offset:5120
    s_waitcnt lgkmcnt(1)
    buffer_store_dwordx4 v[56:59], v12, s[4:7], s50 offen sc1
    s_waitcnt lgkmcnt(0)
    buffer_store_dwordx4 v[60:63], v12, s[4:7], s50 offen offset:1024 sc1
    v_mfma_f32_32x32x16_bf16 v[220:235], v[252:255], v[252:255], 0
    v_mfma_f32_32x32x16_bf16 v[236:251], v[252:255], v[252:255], 0
    v_mov_b32 v6, 1
    s_waitcnt vmcnt(0)
    s_mov_b64 exec, 1
    ds_add_rtn_u32 v6, v11, v6 offset:36
    v_mov_b32 v7, s46
    s_waitcnt lgkmcnt(0)
    v_readfirstlane_b32 s60, v6
    s_cmp_lg_u32 s60, 3
    s_cbranch_scc1 Lgp_43
    buffer_store_dword v7, off, s[4:7], s59 sc1
Lgp_43:
    s_mov_b64 exec, -1
Lpw_44:
    ds_read_b32 v8, v11 offset:0
    s_waitcnt lgkmcnt(0)
    v_readfirstlane_b32 s3, v8
    s_cmp_ge_u32 s3, 4
    s_cbranch_scc1 Lpw_45
    s_branch Lpw_44
Lpw_45:
    ds_write_b64 v23, v[252:253]
    s_mul_i32 s55, s42, 100352
    s_add_u32 s55, s55, s94
    s_mul_i32 s56, s42, 14336
    s_add_u32 s56, s56, 96512
    s_mov_b32 s54, 0
Lwo_46:
    s_mov_b32 m0, s56
    s_add_u32 s56, s56, 1024
    buffer_load_dwordx4 v22, s[16:19], s55 offen lds
    s_add_u32 s55, s55, 7168
    s_add_u32 s54, s54, 1
    s_waitcnt vmcnt(4)
    s_cmp_lt_u32 s54, 14
    s_cbranch_scc1 Lwo_46
    v_mov_b32 v6, 1
    s_waitcnt vmcnt(0)
    s_mov_b64 exec, 1
    ds_add_u32 v11, v6 offset:32
    s_mov_b64 exec, -1
    s_cmp_lg_u32 s60, 3
    s_cbranch_scc1 Lgw_47
    s_mov_b32 exec_hi, 0
    s_mov_b32 s3, 0
Lpoll_49:
    buffer_load_dword v6, v24, s[4:7], 0 offen sc1
    s_add_u32 s3, s3, 1
    s_cmp_gt_u32 s3, 50000
    s_cbranch_scc1 Lpoll_50
    s_waitcnt vmcnt(0)
    v_cmp_ne_u32 vcc, s46, v6
    s_cbranch_vccz Lpoll_50
    s_mov_b64 exec, vcc
    s_bcnt1_i32_b64 s63, vcc
    s_cmp_le_u32 s63, 0
    s_cbranch_scc1 Lpoll_49
    s_sleep 24
    s_branch Lpoll_49
Lpoll_50:
    s_mov_b64 exec, -1
    v_mov_b32 v6, 1
    s_mov_b64 exec, 1
    ds_write_b32 v11, v6 offset:40
    s_mov_b64 exec, -1
    s_branch Lgw_48
Lgw_47:
Lpw_51:
    ds_read_b32 v6, v11 offset:40
    s_waitcnt lgkmcnt(0)
    v_readfirstlane_b32 s3, v6
    s_cmp_ge_u32 s3, 1
    s_cbranch_scc1 Lpw_52
    s_sleep 24
    s_branch Lpw_51
Lpw_52:
Lgw_48:
    s_lshl_b32 s50, s37, 18
    s_lshl_b32 s55, s38, 7
    s_add_u32 s50, s50, s55
    s_lshl_b32 s55, s42, 5
    s_add_u32 s50, s50, s55
    s_add_u32 s50, s50, 10485760
    s_add_u32 s51, s50, 131072
    buffer_load_dwordx4 v[156:159], v16, s[4:7], s50 offen sc1
    buffer_load_dwordx4 v[160:163], v16, s[4:7], s51 offen sc1
    s_lshl_b32 s50, s38, 2
    s_add_u32 s50, s50, s42
    s_mul_i32 s50, s50, 28672
    s_add_u32 s50, s50, s94
    s_add_u32 s50, s50, 896
    s_add_u32 s51, s50, 14336
    s_waitcnt vmcnt(0)
    ds_write_b128 v13, v[156:159] offset:4096
    ds_write_b128 v13, v[160:163] offset:5120
    ds_read_b64_tr_b16 v[156:157], v17 offset:4096
    ds_read_b64_tr_b16 v[158:159], v17 offset:4224
    ds_read_b64_tr_b16 v[160:161], v17 offset:4352
    ds_read_b64_tr_b16 v[162:163], v17 offset:4480
    s_waitcnt lgkmcnt(0)
    ds_write_b128 v18, v[156:159] offset:4096
    ds_write_b128 v18, v[160:163] offset:4112
    ds_read_b128 v[156:159], v19 offset:4096
    ds_read_b128 v[160:163], v19 offset:5248
    s_waitcnt lgkmcnt(1)
    buffer_store_dwordx4 v[156:159], v20, s[24:27], s50 offen sc1
    s_waitcnt lgkmcnt(0)
    buffer_store_dwordx4 v[160:163], v20, s[24:27], s51 offen sc1
    s_lshl_b32 s50, s38, 1
    s_add_u32 s50, s50, s43
    s_lshl_b32 s54, s50, 1
    s_add_u32 s54, s54, s44
    s_mul_i32 s54, s54, 28672
    s_add_u32 s54, s54, s94
    s_add_u32 s57, s54, 14336
    s_lshl_b32 s50, s50, 15
    s_lshl_b32 s53, s44, 11
    s_add_u32 s50, s50, s53
    s_add_u32 s50, s50, 6160384
    s_lshr_b32 s55, s46, 16
    s_mov_b32 s52, 0xff
Lpw_75:
    ds_read_b32 v8, v11 offset:32
    s_waitcnt lgkmcnt(0)
    v_readfirstlane_b32 s3, v8
    s_cmp_ge_u32 s3, 4
    s_cbranch_scc1 Lpw_76
    s_sleep 4
    s_branch Lpw_75
Lpw_76:
Lpw_77:
    ds_read_b32 v8, v11 offset:48
    s_waitcnt lgkmcnt(0)
    v_readfirstlane_b32 s3, v8
    s_cmp_ge_u32 s3, 1
    s_cbranch_scc1 Lpw_78
    s_sleep 24
    s_branch Lpw_77
Lpw_78:
    s_setprio 3
    s_mov_b32 s3, 0
    s_mov_b32 s51, 0
Lop_53:
    s_add_u32 s3, s3, 1
    s_cmp_gt_u32 s3, 50000
    s_cbranch_scc1 Lod_54
    s_andn2_b32 s56, s52, s51
    s_cbranch_scc0 Lon_55
    s_mov_b32 exec_hi, 0
    s_mov_b32 exec_lo, s56
    buffer_load_ushort v7, v3, s[4:7], s50 offen offset:2046 sc1
    s_mov_b64 exec, -1
Lon_55:
    s_bcnt1_i32_b32 s58, s51
    s_cbranch_scc0 Loz_56
    s_cmp_eq_u32 s58, 1
    s_cbranch_scc1 Loi_58
    s_cmp_eq_u32 s58, 2
    s_cbranch_scc1 Loi_59
    s_cmp_eq_u32 s58, 3
    s_cbranch_scc1 Loi_60
    s_cmp_eq_u32 s58, 4
    s_cbranch_scc1 Loi_61
    s_cmp_eq_u32 s58, 5
    s_cbranch_scc1 Loi_62
    s_cmp_eq_u32 s58, 6
    s_cbranch_scc1 Loi_63
    s_cmp_eq_u32 s58, 7
    s_cbranch_scc1 Loi_64
Loi_65:
    s_ff1_i32_b32 s83, s51
    s_bitset0_b32 s51, s83
    s_lshl_b32 s53, s83, 12
    s_add_u32 s53, s53, s50
    buffer_load_dwordx4 v[196:199], v12, s[4:7], s53 offen sc1
    buffer_load_dwordx4 v[200:203], v12, s[4:7], s53 offen offset:1024 sc1
    s_mul_i32 s53, s83, 7168
    v_add_u32 v27, s53, v2
    ds_read_b64_tr_b16 v[204:205], v27 offset:0
    ds_read_b64_tr_b16 v[206:207], v27 offset:512
    ds_read_b64_tr_b16 v[208:209], v27 offset:1792
    ds_read_b64_tr_b16 v[210:211], v27 offset:2304
    ds_read_b64_tr_b16 v[212:213], v27 offset:64
    ds_read_b64_tr_b16 v[214:215], v27 offset:576
    ds_read_b64_tr_b16 v[216:217], v27 offset:1856
    ds_read_b64_tr_b16 v[218:219], v27 offset:2368
Loi_64:
    s_ff1_i32_b32 s82, s51
    s_bitset0_b32 s51, s82
    s_lshl_b32 s53, s82, 12
    s_add_u32 s53, s53, s50
    buffer_load_dwordx4 v[172:175], v12, s[4:7], s53 offen sc1
    buffer_load_dwordx4 v[176:179], v12, s[4:7], s53 offen offset:1024 sc1
    s_mul_i32 s53, s82, 7168
    v_add_u32 v27, s53, v2
    ds_read_b64_tr_b16 v[180:181], v27 offset:0
    ds_read_b64_tr_b16 v[182:183], v27 offset:512
    ds_read_b64_tr_b16 v[184:185], v27 offset:1792
    ds_read_b64_tr_b16 v[186:187], v27 offset:2304
    ds_read_b64_tr_b16 v[188:189], v27 offset:64
    ds_read_b64_tr_b16 v[190:191], v27 offset:576
    ds_read_b64_tr_b16 v[192:193], v27 offset:1856
    ds_read_b64_tr_b16 v[194:195], v27 offset:2368
Loi_63:
    s_ff1_i32_b32 s81, s51
    s_bitset0_b32 s51, s81
    s_lshl_b32 s53, s81, 12
    s_add_u32 s53, s53, s50
    buffer_load_dwordx4 v[148:151], v12, s[4:7], s53 offen sc1
    buffer_load_dwordx4 v[152:155], v12, s[4:7], s53 offen offset:1024 sc1
    s_mul_i32 s53, s81, 7168
    v_add_u32 v27, s53, v2
    ds_read_b64_tr_b16 v[156:157], v27 offset:0
    ds_read_b64_tr_b16 v[158:159], v27 offset:512
    ds_read_b64_tr_b16 v[160:161], v27 offset:1792
    ds_read_b64_tr_b16 v[162:163], v27 offset:2304
    ds_read_b64_tr_b16 v[164:165], v27 offset:64
    ds_read_b64_tr_b16 v[166:167], v27 offset:576
    ds_read_b64_tr_b16 v[168:169], v27 offset:1856
    ds_read_b64_tr_b16 v[170:171], v27 offset:2368
Loi_62:
    s_ff1_i32_b32 s80, s51
    s_bitset0_b32 s51, s80
    s_lshl_b32 s53, s80, 12
    s_add_u32 s53, s53, s50
    buffer_load_dwordx4 v[124:127], v12, s[4:7], s53 offen sc1
    buffer_load_dwordx4 v[128:131], v12, s[4:7], s53 offen offset:1024 sc1
    s_mul_i32 s53, s80, 7168
    v_add_u32 v27, s53, v2
    ds_read_b64_tr_b16 v[132:133], v27 offset:0
    ds_read_b64_tr_b16 v[134:135], v27 offset:512
    ds_read_b64_tr_b16 v[136:137], v27 offset:1792
    ds_read_b64_tr_b16 v[138:139], v27 offset:2304
    ds_read_b64_tr_b16 v[140:141], v27 offset:64
    ds_read_b64_tr_b16 v[142:143], v27 offset:576
    ds_read_b64_tr_b16 v[144:145], v27 offset:1856
    ds_read_b64_tr_b16 v[146:147], v27 offset:2368
Loi_61:
    s_ff1_i32_b32 s79, s51
    s_bitset0_b32 s51, s79
    s_lshl_b32 s53, s79, 12
    s_add_u32 s53, s53, s50
    buffer_load_dwordx4 v[100:103], v12, s[4:7], s53 offen sc1
    buffer_load_dwordx4 v[104:107], v12, s[4:7], s53 offen offset:1024 sc1
    s_mul_i32 s53, s79, 7168
    v_add_u32 v27, s53, v2
    ds_read_b64_tr_b16 v[108:109], v27 offset:0
    ds_read_b64_tr_b16 v[110:111], v27 offset:512
    ds_read_b64_tr_b16 v[112:113], v27 offset:1792
    ds_read_b64_tr_b16 v[114:115], v27 offset:2304
    ds_read_b64_tr_b16 v[116:117], v27 offset:64
    ds_read_b64_tr_b16 v[118:119], v27 offset:576
    ds_read_b64_tr_b16 v[120:121], v27 offset:1856
    ds_read_b64_tr_b16 v[122:123], v27 offset:2368
Loi_60:
    s_ff1_i32_b32 s78, s51
    s_bitset0_b32 s51, s78
    s_lshl_b32 s53, s78, 12
    s_add_u32 s53, s53, s50
    buffer_load_dwordx4 v[76:79], v12, s[4:7], s53 offen sc1
    buffer_load_dwordx4 v[80:83], v12, s[4:7], s53 offen offset:1024 sc1
    s_mul_i32 s53, s78, 7168
    v_add_u32 v27, s53, v2
    ds_read_b64_tr_b16 v[84:85], v27 offset:0
    ds_read_b64_tr_b16 v[86:87], v27 offset:512
    ds_read_b64_tr_b16 v[88:89], v27 offset:1792
    ds_read_b64_tr_b16 v[90:91], v27 offset:2304
    ds_read_b64_tr_b16 v[92:93], v27 offset:64
    ds_read_b64_tr_b16 v[94:95], v27 offset:576
    ds_read_b64_tr_b16 v[96:97], v27 offset:1856
    ds_read_b64_tr_b16 v[98:99], v27 offset:2368
Loi_59:
    s_ff1_i32_b32 s77, s51
    s_bitset0_b32 s51, s77
    s_lshl_b32 s53, s77, 12
    s_add_u32 s53, s53, s50
    buffer_load_dwordx4 v[52:55], v12, s[4:7], s53 offen sc1
    buffer_load_dwordx4 v[56:59], v12, s[4:7], s53 offen offset:1024 sc1
    s_mul_i32 s53, s77, 7168
    v_add_u32 v27, s53, v2
    ds_read_b64_tr_b16 v[60:61], v27 offset:0
    ds_read_b64_tr_b16 v[62:63], v27 offset:512
    ds_read_b64_tr_b16 v[64:65], v27 offset:1792
    ds_read_b64_tr_b16 v[66:67], v27 offset:2304
    ds_read_b64_tr_b16 v[68:69], v27 offset:64
    ds_read_b64_tr_b16 v[70:71], v27 offset:576
    ds_read_b64_tr_b16 v[72:73], v27 offset:1856
    ds_read_b64_tr_b16 v[74:75], v27 offset:2368
Loi_58:
    s_ff1_i32_b32 s76, s51
    s_bitset0_b32 s51, s76
    s_lshl_b32 s53, s76, 12
    s_add_u32 s53, s53, s50
    buffer_load_dwordx4 v[28:31], v12, s[4:7], s53 offen sc1
    buffer_load_dwordx4 v[32:35], v12, s[4:7], s53 offen offset:1024 sc1
    s_mul_i32 s53, s76, 7168
    v_add_u32 v27, s53, v2
    ds_read_b64_tr_b16 v[36:37], v27 offset:0
    ds_read_b64_tr_b16 v[38:39], v27 offset:512
    ds_read_b64_tr_b16 v[40:41], v27 offset:1792
    ds_read_b64_tr_b16 v[42:43], v27 offset:2304
    ds_read_b64_tr_b16 v[44:45], v27 offset:64
    ds_read_b64_tr_b16 v[46:47], v27 offset:576
    ds_read_b64_tr_b16 v[48:49], v27 offset:1856
    ds_read_b64_tr_b16 v[50:51], v27 offset:2368
    s_waitcnt lgkmcnt(0)
    s_cmp_eq_u32 s58, 1
    s_cbranch_scc1 Low_67
    s_cmp_eq_u32 s58, 2
    s_cbranch_scc1 Low_68
    s_cmp_eq_u32 s58, 3
    s_cbranch_scc1 Low_69
    s_cmp_eq_u32 s58, 4
    s_cbranch_scc1 Low_70
    s_cmp_eq_u32 s58, 5
    s_cbranch_scc1 Low_71
    s_cmp_eq_u32 s58, 6
    s_cbranch_scc1 Low_72
    s_cmp_eq_u32 s58, 7
    s_cbranch_scc1 Low_73
Low_74:
    s_waitcnt vmcnt(14)
    v_xor_b32 v199, v199, v5
    v_xor_b32 v203, v203, v5
    v_or_b32 v6, v199, v203
    v_cmp_lt_u32 vcc, 0xffff, v6
    s_cbranch_vccnz Low_73
    s_bitset0_b32 s52, s83
    v_mfma_f32_32x32x16_bf16 v[220:235], v[204:207], v[196:199], v[220:235]
    v_mfma_f32_32x32x16_bf16 v[236:251], v[212:215], v[196:199], v[236:251]
    v_mfma_f32_32x32x16_bf16 v[220:235], v[208:211], v[200:203], v[220:235]
    v_mfma_f32_32x32x16_bf16 v[236:251], v[216:219], v[200:203], v[236:251]
Low_73:
    s_waitcnt vmcnt(12)
    v_xor_b32 v175, v175, v5
    v_xor_b32 v179, v179, v5
    v_or_b32 v6, v175, v179
    v_cmp_lt_u32 vcc, 0xffff, v6
    s_cbranch_vccnz Low_72
    s_bitset0_b32 s52, s82
    v_mfma_f32_32x32x16_bf16 v[220:235], v[180:183], v[172:175], v[220:235]
    v_mfma_f32_32x32x16_bf16 v[236:251], v[188:191], v[172:175], v[236:251]
    v_mfma_f32_32x32x16_bf16 v[220:235], v[184:187], v[176:179], v[220:235]
    v_mfma_f32_32x32x16_bf16 v[236:251], v[192:195], v[176:179], v[236:251]
Low_72:
    s_waitcnt vmcnt(10)
    v_xor_b32 v151, v151, v5
    v_xor_b32 v155, v155, v5
    v_or_b32 v6, v151, v155
    v_cmp_lt_u32 vcc, 0xffff, v6
    s_cbranch_vccnz Low_71
    s_bitset0_b32 s52, s81
    v_mfma_f32_32x32x16_bf16 v[220:235], v[156:159], v[148:151], v[220:235]
    v_mfma_f32_32x32x16_bf16 v[236:251], v[164:167], v[148:151], v[236:251]
    v_mfma_f32_32x32x16_bf16 v[220:235], v[160:163], v[152:155], v[220:235]
    v_mfma_f32_32x32x16_bf16 v[236:251], v[168:171], v[152:155], v[236:251]
Low_71:
    s_waitcnt vmcnt(8)
    v_xor_b32 v127, v127, v5
    v_xor_b32 v131, v131, v5
    v_or_b32 v6, v127, v131
    v_cmp_lt_u32 vcc, 0xffff, v6
    s_cbranch_vccnz Low_70
    s_bitset0_b32 s52, s80
    v_mfma_f32_32x32x16_bf16 v[220:235], v[132:135], v[124:127], v[220:235]
    v_mfma_f32_32x32x16_bf16 v[236:251], v[140:143], v[124:127], v[236:251]
    v_mfma_f32_32x32x16_bf16 v[220:235], v[136:139], v[128:131], v[220:235]
    v_mfma_f32_32x32x16_bf16 v[236:251], v[144:147], v[128:131], v[236:251]
Low_70:
    s_waitcnt vmcnt(6)
    v_xor_b32 v103, v103, v5
    v_xor_b32 v107, v107, v5
    v_or_b32 v6, v103, v107
    v_cmp_lt_u32 vcc, 0xffff, v6
    s_cbranch_vccnz Low_69
    s_bitset0_b32 s52, s79
    v_mfma_f32_32x32x16_bf16 v[220:235], v[108:111], v[100:103], v[220:235]
    v_mfma_f32_32x32x16_bf16 v[236:251], v[116:119], v[100:103], v[236:251]
    v_mfma_f32_32x32x16_bf16 v[220:235], v[112:115], v[104:107], v[220:235]
    v_mfma_f32_32x32x16_bf16 v[236:251], v[120:123], v[104:107], v[236:251]
Low_69:
    s_waitcnt vmcnt(4)
    v_xor_b32 v79, v79, v5
    v_xor_b32 v83, v83, v5
    v_or_b32 v6, v79, v83
    v_cmp_lt_u32 vcc, 0xffff, v6
    s_cbranch_vccnz Low_68
    s_bitset0_b32 s52, s78
    v_mfma_f32_32x32x16_bf16 v[220:235], v[84:87], v[76:79], v[220:235]
    v_mfma_f32_32x32x16_bf16 v[236:251], v[92:95], v[76:79], v[236:251]
    v_mfma_f32_32x32x16_bf16 v[220:235], v[88:91], v[80:83], v[220:235]
    v_mfma_f32_32x32x16_bf16 v[236:251], v[96:99], v[80:83], v[236:251]
Low_68:
    s_waitcnt vmcnt(2)
    v_xor_b32 v55, v55, v5
    v_xor_b32 v59, v59, v5
    v_or_b32 v6, v55, v59
    v_cmp_lt_u32 vcc, 0xffff, v6
    s_cbranch_vccnz Low_67
    s_bitset0_b32 s52, s77
    v_mfma_f32_32x32x16_bf16 v[220:235], v[60:63], v[52:55], v[220:235]
    v_mfma_f32_32x32x16_bf16 v[236:251], v[68:71], v[52:55], v[236:251]
    v_mfma_f32_32x32x16_bf16 v[220:235], v[64:67], v[56:59], v[220:235]
    v_mfma_f32_32x32x16_bf16 v[236:251], v[72:75], v[56:59], v[236:251]
Low_67:
    s_waitcnt vmcnt(0)
    v_xor_b32 v31, v31, v5
    v_xor_b32 v35, v35, v5
    v_or_b32 v6, v31, v35
    v_cmp_lt_u32 vcc, 0xffff, v6
    s_cbranch_vccnz Low_66
    s_bitset0_b32 s52, s76
    v_mfma_f32_32x32x16_bf16 v[220:235], v[36:39], v[28:31], v[220:235]
    v_mfma_f32_32x32x16_bf16 v[236:251], v[44:47], v[28:31], v[236:251]
    v_mfma_f32_32x32x16_bf16 v[220:235], v[40:43], v[32:35], v[220:235]
    v_mfma_f32_32x32x16_bf16 v[236:251], v[48:51], v[32:35], v[236:251]
Low_66:
    s_cmp_eq_u32 s52, 0
    s_cbranch_scc1 Lod_54
    v_cmp_eq_u32 vcc, s55, v7
    s_and_b32 s51, vcc_lo, s56
    s_branch Lop_53
Loz_56:
    s_waitcnt vmcnt(0)
    v_cmp_eq_u32 vcc, s55, v7
    s_and_b32 s51, vcc_lo, s56
    s_cbranch_scc1 Lop_53
    s_sleep 6
    s_branch Lop_53
Lod_54:
    s_mov_b64 exec, -1
    s_nop 7
    ds_write_b128 v4, v[220:223] offset:0
    ds_write_b128 v4, v[224:227] offset:16
    ds_write_b128 v4, v[228:231] offset:32
    ds_write_b128 v4, v[232:235] offset:48
    ds_write_b128 v4, v[236:239] offset:128
    ds_write_b128 v4, v[240:243] offset:144
    ds_write_b128 v4, v[244:247] offset:160
    ds_write_b128 v4, v[248:251] offset:176
    v_mov_b32 v8, 6
    s_mov_b64 exec, 1
    ds_write_b32 v9, v8
    s_mov_b64 exec, -1
Lpw_79:
    ds_read_b32 v8, v10 offset:0
    s_waitcnt lgkmcnt(0)
    v_readfirstlane_b32 s3, v8
    s_cmp_ge_u32 s3, 6
    s_cbranch_scc1 Lpw_80
    s_branch Lpw_79
Lpw_80:
    ds_read_b128 v[28:31], v25 offset:0
    ds_read_b128 v[32:35], v25 offset:16
    ds_read_b128 v[36:39], v25 offset:8704
    ds_read_b128 v[40:43], v25 offset:8720
    ds_read_b128 v[44:47], v25 offset:2176
    ds_read_b128 v[48:51], v25 offset:2192
    ds_read_b128 v[52:55], v25 offset:10880
    ds_read_b128 v[56:59], v25 offset:10896
    s_waitcnt lgkmcnt(4)
    v_pk_add_f32 v[28:29], v[28:29], v[36:37]
    v_pk_add_f32 v[30:31], v[30:31], v[38:39]
    v_pk_add_f32 v[32:33], v[32:33], v[40:41]
    v_pk_add_f32 v[34:35], v[34:35], v[42:43]
    v_cvt_pk_bf16_f32 v28, v28, v29
    v_cvt_pk_bf16_f32 v29, v30, v31
    v_cvt_pk_bf16_f32 v30, v32, v33
    v_cvt_pk_bf16_f32 v31, v34, v35
    buffer_store_dwordx4 v[28:31], v20, s[24:27], s54 offen sc1
    s_waitcnt lgkmcnt(0)
    v_pk_add_f32 v[44:45], v[44:45], v[52:53]
    v_pk_add_f32 v[46:47], v[46:47], v[54:55]
    v_pk_add_f32 v[48:49], v[48:49], v[56:57]
    v_pk_add_f32 v[50:51], v[50:51], v[58:59]
    v_cvt_pk_bf16_f32 v44, v44, v45
    v_cvt_pk_bf16_f32 v45, v46, v47
    v_cvt_pk_bf16_f32 v46, v48, v49
    v_cvt_pk_bf16_f32 v47, v50, v51
    buffer_store_dwordx4 v[44:47], v20, s[24:27], s57 offen sc1
    s_endpgm
L_idle:
    s_cmp_ge_u32 s36, 4
    s_cbranch_scc1 Lw7_81
    s_lshl_b32 s55, s2, 7
    s_add_u32 s55, s55, 12840960
    v_mov_b32 v12, s55
    v_mov_b32 v13, 0
    s_waitcnt lgkmcnt(0)
    s_mov_b32 s4, s88
    s_mov_b32 s5, s89
    s_mov_b32 s6, 16777216
    s_mov_b32 s7, 0x00020000
    s_mov_b32 s28, s86
    s_mov_b32 s29, s87
    s_mov_b32 s30, 256
    s_mov_b32 s31, 0x00020000
    s_barrier
    s_mov_b32 s3, 0
    s_waitcnt vmcnt(0)
Lnon_82:
    v_readfirstlane_b32 s46, v13
    s_add_u32 s3, s3, 1
    s_cmp_lg_u32 s46, 0
    s_cbranch_scc1 Lnon_83
    s_cmp_gt_u32 s3, 50000
    s_cbranch_scc1 Lnon_83
    s_sleep 8
    buffer_load_dword v13, off, s[28:31], 0 sc1
    s_waitcnt vmcnt(0)
    s_branch Lnon_82
Lnon_83:
    s_mov_b64 exec, 1
    s_mov_b32 s3, 0
Lpoll_84:
    buffer_load_dword v13, v12, s[4:7], 0 offen sc1
    s_add_u32 s3, s3, 1
    s_cmp_gt_u32 s3, 50000
    s_cbranch_scc1 Lpoll_85
    s_waitcnt vmcnt(0)
    v_cmp_ne_u32 vcc, s46, v13
    s_cbranch_vccz Lpoll_85
    s_mov_b64 exec, vcc
    s_bcnt1_i32_b64 s63, vcc
    s_cmp_le_u32 s63, 0
    s_cbranch_scc1 Lpoll_84
    s_sleep 8
    s_branch Lpoll_84
Lpoll_85:
    s_mov_b64 exec, -1
    s_branch L_attn
Lw7_81:
    s_cmp_lg_u32 s36, 7
    s_cbranch_scc1 L_end
    s_cmp_lg_u32 s2, 0
    s_cbranch_scc1 L_end
    s_memrealtime s[60:61]
    s_waitcnt lgkmcnt(0)
    s_mov_b32 s28, s86
    s_mov_b32 s29, s87
    s_mov_b32 s30, 256
    s_mov_b32 s31, 0x00020000
    s_mul_i32 s60, s60, 0x9e3779b1
    s_or_b32 s60, s60, 1
    v_mov_b32 v8, s60
    s_mov_b64 exec, 1
    buffer_store_dword v8, off, s[28:31], 0 sc1
    s_endpgm
L_end:
    s_endpgm
.section .rodata,"a"
.p2align 6
.amdhsa_kernel concat_heads__mha_block__ssm_conv_s4d__prompt_kernel
  .amdhsa_next_free_vgpr 256
  .amdhsa_next_free_sgpr 102
  .amdhsa_accum_offset 256
  .amdhsa_group_segment_fixed_size 0
  .amdhsa_kernarg_size 104
  .amdhsa_user_sgpr_count 2
  .amdhsa_user_sgpr_kernarg_segment_ptr 1
  .amdhsa_system_sgpr_workgroup_id_x 1
.end_amdhsa_kernel
```
